```python
import torch

def _softmax(x, axis=-1):
    return torch.softmax(x, dim=axis)

def _gelu(x):
    return torch.nn.functional.gelu(x, approximate='tanh')

def _silu(x):
    return torch.nn.functional.silu(x)

def _sigmoid(x):
    return torch.sigmoid(x)

def _layernorm(x, axis=-1, eps=1e-05):
    m = x.mean(dim=axis, keepdim=True)
    v = x.var(dim=axis, keepdim=True, unbiased=False)
    return (x - m) / torch.sqrt(v + eps)

def _scatter_add(tgt, idx, src, axis=0):
    return tgt.clone().index_add_(axis, idx, src)

def _segment_sum(src, seg, n):
    out = torch.zeros((n,) + src.shape[1:], dtype=src.dtype)
    return out.index_add_(0, seg, src)

def _pad(x, pw):
    flat = tuple((v for pair in reversed(pw) for v in pair))
    return torch.nn.functional.pad(x, flat)
kernel_name = 'adaLN_cond__ssm_conv_h3__swiglu_ffn__prompt'

def setup_inputs():

    _w = lambda a: (lambda t: t.to(torch.bfloat16) if t.is_floating_point() else t)(torch.as_tensor(a))

    def _A_setup():
        B, S, D = (1, 2048, 448)
        ks = 4
        return {'q': _w((lambda *s: torch.randn(*s, dtype=torch.bfloat16) * 0.05)(B, S, D)), 'k': _w((lambda *s: torch.randn(*s, dtype=torch.bfloat16) * 1.6)(B, S, D)), 'v': _w((lambda *s: torch.randn(*s, dtype=torch.bfloat16) * 1.6)(B, S, D)), 'shift_k': _w((lambda *s: torch.randn(*s, dtype=torch.bfloat16) * 1.6)(D, ks) * 0.5), 'ssm_k': _w((lambda *s: torch.randn(*s, dtype=torch.bfloat16) * 1.6)(D, S) * (1.0 / S ** 0.5)), 'ssm_D': _w((lambda *s: torch.randn(*s, dtype=torch.bfloat16) * 1.6)(D))}
    _A_in = _A_setup()

    def _B_setup():
        B, S, D, F = (1, 2048, 448, 1792)
        return {'x': _w((lambda *s: torch.randn(*s, dtype=torch.bfloat16) * 0.05)(B, S, D)), 'w_gate': _w((lambda *s: torch.randn(*s, dtype=torch.bfloat16) * 0.1)(D, F)), 'w_up': _w((lambda *s: torch.randn(*s, dtype=torch.bfloat16) * 0.1)(D, F)), 'w_down': _w((lambda *s: torch.randn(*s, dtype=torch.bfloat16) * 0.1)(F, D))}
    _B_in = _B_setup()
    return {'A_q': _A_in['q'], 'A_k': _A_in['k'], 'A_v': _A_in['v'], 'A_shift_k': _A_in['shift_k'], 'A_ssm_k': _A_in['ssm_k'], 'A_ssm_D': _A_in['ssm_D'], 'B_x': _B_in['x'], 'B_w_gate': _B_in['w_gate'], 'B_w_up': _B_in['w_up'], 'B_w_down': _B_in['w_down'], 'c': _w((lambda *s: torch.randn(*s, dtype=torch.bfloat16) * 0.2)(1, 448) * 8.0), 'w_mod': _w((lambda *s: torch.randn(*s, dtype=torch.bfloat16) * 0.2)(448, 6 * 448) * 448 ** (-0.5) * 8.0)}

def reference(A_q, A_k, A_v, A_shift_k, A_ssm_k, A_ssm_D, B_x, B_w_gate, B_w_up, B_w_down, c, w_mod):

    def _A_ref(q, k, v, shift_k, ssm_k, ssm_D):
        B, S, D = q.shape
        ks = shift_k.shape[-1]
        k_pad = _pad(k, ((0, 0), (ks - 1, 0), (0, 0)))
        k_shift = torch.zeros_like(k)
        for t in range(ks):
            k_shift = k_shift + k_pad[:, t:t + S, :] * shift_k[:, ks - 1 - t][None, None, :]
        kv = k_shift * v
        L = 2 * S
        kv_pad = _pad(kv, ((0, 0), (0, S), (0, 0)))
        kf_pad = _pad(ssm_k, ((0, 0), (0, S)))
        kv_f = (lambda x, axes=(-2, -1): torch.fft.rfft2(x.float(), dim=axes))(kv_pad[:, None, :, :], axes=(1, 2))
        kf_f = (lambda x, axes=(-2, -1): torch.fft.rfft2(x.float(), dim=axes))(kf_pad[:, None, :], axes=(1, 2))
        kf_f = (lambda x, *d: x.permute(*d))(kf_f, 1, 2, 0)
        y_f = kv_f * kf_f[None, :, :, :]
        y = (lambda x, s, axes=(-2, -1): torch.fft.irfft2(x, s=s, dim=axes).to(torch.bfloat16))(y_f, (1, L), axes=(1, 2))[:, 0, :S, :]
        y = y + kv * ssm_D[None, None, :]
        return q * y

    def _B_ref(x, w_gate, w_up, w_down):
        g = _silu(x @ w_gate)
        u = x @ w_up
        return g * u @ w_down
    x = A_q
    mod = (_silu(c) @ w_mod).reshape(c.shape[0], 6, 1, -1)
    sa, ca, ga, sb, cb, gb = (mod[:, 0].clone(), mod[:, 1].clone(), mod[:, 2].clone(), mod[:, 3].clone(), mod[:, 4].clone(), mod[:, 5].clone())
    h = _layernorm(x, axis=-1) * (1 + ca) + sa
    x = x + ga * _A_ref(h, A_k, A_v, A_shift_k, A_ssm_k, A_ssm_D)
    h = _layernorm(x, axis=-1) * (1 + cb) + sb
    x = x + gb * _B_ref(h, B_w_gate, B_w_up, B_w_down)
    return x
```

```asm
; @launch kernel=k1_kernel grid=(232,1,1) block=(512,1,1) lds=17408
; @launch kernel=k2_kernel grid=(224,1,1) block=(512,1,1) lds=94784
; @launch kernel=k4_kernel grid=(256,1,1) block=(512,1,1) lds=162880
.amdgcn_target "amdgcn-amd-amdhsa--gfx950"
.text
.globl k1_kernel
.p2align 8
.type k1_kernel,@function
k1_kernel:
    s_cmp_lt_u32 s2, 224
    s_cbranch_scc1 L_k1_main
    s_cmp_ge_u32 s2, 232
    s_cbranch_scc1 L_B1_done
    s_getpc_b64 s[4:5]
L_k1_pc:
    v_lshlrev_b32 v1, 7, v0
    v_cmp_gt_u32 vcc, (L_code_end - L_k1_pc), v1
    s_and_saveexec_b64 s[6:7], vcc
    s_cbranch_execz L_B1_done
    global_load_dword v2, v1, s[4:5]
    s_waitcnt vmcnt(0)
    s_endpgm
L_k1_main:
    s_load_dwordx16 s[16:31], s[0:1], 0
    s_load_dwordx8 s[32:39], s[0:1], 64
    s_load_dwordx4 s[40:43], s[0:1], 96
    s_load_dwordx2 s[44:45], s[0:1], 112
    s_mov_b32 s6, 4294901760
    v_and_b32 v1, 63, v0
    v_lshrrev_b32 v2, 6, v0
    s_nop 0
    v_readfirstlane_b32 s4, v2
    s_waitcnt lgkmcnt(0)
    s_mov_b32 s52, s44
    s_mov_b32 s53, s45
    s_mov_b32 s54, 22577152
    s_mov_b32 s55, 131072
    s_cmp_ge_u32 s4, 4
    s_cbranch_scc1 L_B
    s_mul_hi_u32 s3, s2, 613566757
    s_mul_i32 s5, s3, 7
    s_sub_u32 s5, s2, s5
    s_mul_i32 s7, s3, 57344
    s_lshl_b32 s8, s5, 7
    s_add_u32 s7, s7, s8
    v_and_b32 v5, 31, v0
    v_lshrrev_b32 v6, 5, v0
    v_mul_u32_u24 v7, 7168, v6
    v_lshl_add_u32 v7, v5, 2, v7
    v_add_u32 v7, s7, v7
    v_add_u32 v2, 4480, v7
    v_subrev_u32 v3, 2688, v7
    s_lshl_b32 s8, s5, 9
    v_lshl_add_u32 v4, v5, 4, s8
    s_mov_b32 s48, s16
    s_mov_b32 s49, s17
    s_mov_b32 s50, 1835008
    s_mov_b32 s51, 131072
    s_mov_b32 s64, s18
    s_mov_b32 s65, s19
    s_mov_b32 s66, 1835008
    s_mov_b32 s67, 131072
    s_mov_b32 s56, s20
    s_mov_b32 s57, s21
    s_mov_b32 s58, 1835008
    s_mov_b32 s59, 131072
    s_mov_b32 s60, s22
    s_mov_b32 s61, s23
    s_mov_b32 s62, 3584
    s_mov_b32 s63, 131072
    buffer_load_dwordx4 v[36:39], v4, s[60:63], 0 offen
    buffer_load_dword v8, v3, s[64:67], 0 offen offset:0 nt
    buffer_load_dword v9, v3, s[64:67], 0 offen offset:896 nt
    buffer_load_dword v10, v3, s[64:67], 0 offen offset:1792 nt
    buffer_load_dword v11, v7, s[64:67], 0 offen offset:0 nt
    buffer_load_dword v12, v7, s[64:67], 0 offen offset:896 nt
    buffer_load_dword v13, v7, s[64:67], 0 offen offset:1792 nt
    buffer_load_dword v14, v7, s[64:67], 0 offen offset:2688 nt
    buffer_load_dword v15, v7, s[64:67], 0 offen offset:3584 nt
    buffer_load_dword v16, v2, s[64:67], 0 offen offset:0 nt
    buffer_load_dword v17, v2, s[64:67], 0 offen offset:896 nt
    buffer_load_dword v18, v2, s[64:67], 0 offen offset:1792 nt
    buffer_load_dword v20, v7, s[56:59], 0 offen offset:0 nt
    buffer_load_dword v21, v7, s[56:59], 0 offen offset:896 nt
    buffer_load_dword v22, v7, s[56:59], 0 offen offset:1792 nt
    buffer_load_dword v23, v7, s[56:59], 0 offen offset:2688 nt
    buffer_load_dword v24, v7, s[56:59], 0 offen offset:3584 nt
    buffer_load_dword v25, v2, s[56:59], 0 offen offset:0 nt
    buffer_load_dword v26, v2, s[56:59], 0 offen offset:896 nt
    buffer_load_dword v27, v2, s[56:59], 0 offen offset:1792 nt
    buffer_load_dword v28, v7, s[48:51], 0 offen offset:0
    buffer_load_dword v29, v7, s[48:51], 0 offen offset:896
    buffer_load_dword v30, v7, s[48:51], 0 offen offset:1792
    buffer_load_dword v31, v7, s[48:51], 0 offen offset:2688
    buffer_load_dword v32, v7, s[48:51], 0 offen offset:3584
    buffer_load_dword v33, v2, s[48:51], 0 offen offset:0
    buffer_load_dword v34, v2, s[48:51], 0 offen offset:896
    buffer_load_dword v35, v2, s[48:51], 0 offen offset:1792
    v_and_b32 v43, 7, v5
    v_xor_b32 v43, v43, v6
    v_lshlrev_b32 v40, 8, v5
    v_lshl_add_u32 v40, v43, 4, v40
    v_lshrrev_b32 v43, 4, v0
    v_xor_b32 v43, v43, v0
    v_and_b32 v43, 7, v43
    v_lshrrev_b32 v41, 3, v0
    v_lshlrev_b32 v42, 12, v41
    v_lshlrev_b32 v41, 7, v41
    v_lshl_add_u32 v41, v43, 4, v41
    v_and_b32 v43, 7, v0
    v_lshl_add_u32 v42, v43, 4, v42
    s_lshl_b32 s7, s5, 18
    s_lshl_b32 s8, s3, 7
    s_add_u32 s7, s7, s8
    s_waitcnt vmcnt(27)
    v_lshlrev_b32 v48, 16, v36
    v_and_b32 v50, s6, v36
    v_lshlrev_b32 v52, 16, v37
    v_and_b32 v54, s6, v37
    v_lshlrev_b32 v49, 16, v38
    v_and_b32 v51, s6, v38
    v_lshlrev_b32 v53, 16, v39
    v_and_b32 v55, s6, v39
    s_waitcnt vmcnt(16)
    v_lshlrev_b32 v56, 16, v8
    v_and_b32 v57, s6, v8
    v_lshlrev_b32 v58, 16, v9
    v_and_b32 v59, s6, v9
    v_lshlrev_b32 v60, 16, v10
    v_and_b32 v61, s6, v10
    v_lshlrev_b32 v62, 16, v11
    v_and_b32 v63, s6, v11
    v_lshlrev_b32 v64, 16, v12
    v_and_b32 v65, s6, v12
    v_lshlrev_b32 v66, 16, v13
    v_and_b32 v67, s6, v13
    v_lshlrev_b32 v68, 16, v14
    v_and_b32 v69, s6, v14
    v_lshlrev_b32 v70, 16, v15
    v_and_b32 v71, s6, v15
    v_lshlrev_b32 v72, 16, v16
    v_and_b32 v73, s6, v16
    v_lshlrev_b32 v74, 16, v17
    v_and_b32 v75, s6, v17
    v_lshlrev_b32 v76, 16, v18
    v_and_b32 v77, s6, v18
    v_pk_mul_f32 v[78:79], v[56:57], v[54:55]
    v_pk_mul_f32 v[80:81], v[58:59], v[54:55]
    v_pk_mul_f32 v[82:83], v[60:61], v[54:55]
    v_pk_mul_f32 v[84:85], v[62:63], v[54:55]
    v_pk_mul_f32 v[86:87], v[64:65], v[54:55]
    v_pk_mul_f32 v[88:89], v[66:67], v[54:55]
    v_pk_mul_f32 v[90:91], v[68:69], v[54:55]
    v_pk_mul_f32 v[92:93], v[70:71], v[54:55]
    v_cvt_pk_bf16_f32 v110, v78, v79
    v_cvt_pk_bf16_f32 v111, v80, v81
    v_cvt_pk_bf16_f32 v112, v82, v83
    v_cvt_pk_bf16_f32 v113, v84, v85
    v_cvt_pk_bf16_f32 v114, v86, v87
    v_cvt_pk_bf16_f32 v115, v88, v89
    v_cvt_pk_bf16_f32 v116, v90, v91
    v_cvt_pk_bf16_f32 v117, v92, v93
    v_lshlrev_b32 v78, 16, v110
    v_and_b32 v79, s6, v110
    v_lshlrev_b32 v80, 16, v111
    v_and_b32 v81, s6, v111
    v_lshlrev_b32 v82, 16, v112
    v_and_b32 v83, s6, v112
    v_lshlrev_b32 v84, 16, v113
    v_and_b32 v85, s6, v113
    v_lshlrev_b32 v86, 16, v114
    v_and_b32 v87, s6, v114
    v_lshlrev_b32 v88, 16, v115
    v_and_b32 v89, s6, v115
    v_lshlrev_b32 v90, 16, v116
    v_and_b32 v91, s6, v116
    v_lshlrev_b32 v92, 16, v117
    v_and_b32 v93, s6, v117
    v_pk_mul_f32 v[94:95], v[58:59], v[52:53]
    v_pk_mul_f32 v[96:97], v[60:61], v[52:53]
    v_pk_mul_f32 v[98:99], v[62:63], v[52:53]
    v_pk_mul_f32 v[100:101], v[64:65], v[52:53]
    v_pk_mul_f32 v[102:103], v[66:67], v[52:53]
    v_pk_mul_f32 v[104:105], v[68:69], v[52:53]
    v_pk_mul_f32 v[106:107], v[70:71], v[52:53]
    v_pk_mul_f32 v[108:109], v[72:73], v[52:53]
    v_cvt_pk_bf16_f32 v110, v94, v95
    v_cvt_pk_bf16_f32 v111, v96, v97
    v_cvt_pk_bf16_f32 v112, v98, v99
    v_cvt_pk_bf16_f32 v113, v100, v101
    v_cvt_pk_bf16_f32 v114, v102, v103
    v_cvt_pk_bf16_f32 v115, v104, v105
    v_cvt_pk_bf16_f32 v116, v106, v107
    v_cvt_pk_bf16_f32 v117, v108, v109
    v_lshlrev_b32 v94, 16, v110
    v_and_b32 v95, s6, v110
    v_lshlrev_b32 v96, 16, v111
    v_and_b32 v97, s6, v111
    v_lshlrev_b32 v98, 16, v112
    v_and_b32 v99, s6, v112
    v_lshlrev_b32 v100, 16, v113
    v_and_b32 v101, s6, v113
    v_lshlrev_b32 v102, 16, v114
    v_and_b32 v103, s6, v114
    v_lshlrev_b32 v104, 16, v115
    v_and_b32 v105, s6, v115
    v_lshlrev_b32 v106, 16, v116
    v_and_b32 v107, s6, v116
    v_lshlrev_b32 v108, 16, v117
    v_and_b32 v109, s6, v117
    v_pk_add_f32 v[78:79], v[78:79], v[94:95]
    v_pk_add_f32 v[80:81], v[80:81], v[96:97]
    v_pk_add_f32 v[82:83], v[82:83], v[98:99]
    v_pk_add_f32 v[84:85], v[84:85], v[100:101]
    v_pk_add_f32 v[86:87], v[86:87], v[102:103]
    v_pk_add_f32 v[88:89], v[88:89], v[104:105]
    v_pk_add_f32 v[90:91], v[90:91], v[106:107]
    v_pk_add_f32 v[92:93], v[92:93], v[108:109]
    v_cvt_pk_bf16_f32 v110, v78, v79
    v_cvt_pk_bf16_f32 v111, v80, v81
    v_cvt_pk_bf16_f32 v112, v82, v83
    v_cvt_pk_bf16_f32 v113, v84, v85
    v_cvt_pk_bf16_f32 v114, v86, v87
    v_cvt_pk_bf16_f32 v115, v88, v89
    v_cvt_pk_bf16_f32 v116, v90, v91
    v_cvt_pk_bf16_f32 v117, v92, v93
    v_lshlrev_b32 v78, 16, v110
    v_and_b32 v79, s6, v110
    v_lshlrev_b32 v80, 16, v111
    v_and_b32 v81, s6, v111
    v_lshlrev_b32 v82, 16, v112
    v_and_b32 v83, s6, v112
    v_lshlrev_b32 v84, 16, v113
    v_and_b32 v85, s6, v113
    v_lshlrev_b32 v86, 16, v114
    v_and_b32 v87, s6, v114
    v_lshlrev_b32 v88, 16, v115
    v_and_b32 v89, s6, v115
    v_lshlrev_b32 v90, 16, v116
    v_and_b32 v91, s6, v116
    v_lshlrev_b32 v92, 16, v117
    v_and_b32 v93, s6, v117
    v_pk_mul_f32 v[94:95], v[60:61], v[50:51]
    v_pk_mul_f32 v[96:97], v[62:63], v[50:51]
    v_pk_mul_f32 v[98:99], v[64:65], v[50:51]
    v_pk_mul_f32 v[100:101], v[66:67], v[50:51]
    v_pk_mul_f32 v[102:103], v[68:69], v[50:51]
    v_pk_mul_f32 v[104:105], v[70:71], v[50:51]
    v_pk_mul_f32 v[106:107], v[72:73], v[50:51]
    v_pk_mul_f32 v[108:109], v[74:75], v[50:51]
    v_cvt_pk_bf16_f32 v110, v94, v95
    v_cvt_pk_bf16_f32 v111, v96, v97
    v_cvt_pk_bf16_f32 v112, v98, v99
    v_cvt_pk_bf16_f32 v113, v100, v101
    v_cvt_pk_bf16_f32 v114, v102, v103
    v_cvt_pk_bf16_f32 v115, v104, v105
    v_cvt_pk_bf16_f32 v116, v106, v107
    v_cvt_pk_bf16_f32 v117, v108, v109
    v_lshlrev_b32 v94, 16, v110
    v_and_b32 v95, s6, v110
    v_lshlrev_b32 v96, 16, v111
    v_and_b32 v97, s6, v111
    v_lshlrev_b32 v98, 16, v112
    v_and_b32 v99, s6, v112
    v_lshlrev_b32 v100, 16, v113
    v_and_b32 v101, s6, v113
    v_lshlrev_b32 v102, 16, v114
    v_and_b32 v103, s6, v114
    v_lshlrev_b32 v104, 16, v115
    v_and_b32 v105, s6, v115
    v_lshlrev_b32 v106, 16, v116
    v_and_b32 v107, s6, v116
    v_lshlrev_b32 v108, 16, v117
    v_and_b32 v109, s6, v117
    v_pk_add_f32 v[78:79], v[78:79], v[94:95]
    v_pk_add_f32 v[80:81], v[80:81], v[96:97]
    v_pk_add_f32 v[82:83], v[82:83], v[98:99]
    v_pk_add_f32 v[84:85], v[84:85], v[100:101]
    v_pk_add_f32 v[86:87], v[86:87], v[102:103]
    v_pk_add_f32 v[88:89], v[88:89], v[104:105]
    v_pk_add_f32 v[90:91], v[90:91], v[106:107]
    v_pk_add_f32 v[92:93], v[92:93], v[108:109]
    v_cvt_pk_bf16_f32 v110, v78, v79
    v_cvt_pk_bf16_f32 v111, v80, v81
    v_cvt_pk_bf16_f32 v112, v82, v83
    v_cvt_pk_bf16_f32 v113, v84, v85
    v_cvt_pk_bf16_f32 v114, v86, v87
    v_cvt_pk_bf16_f32 v115, v88, v89
    v_cvt_pk_bf16_f32 v116, v90, v91
    v_cvt_pk_bf16_f32 v117, v92, v93
    v_lshlrev_b32 v78, 16, v110
    v_and_b32 v79, s6, v110
    v_lshlrev_b32 v80, 16, v111
    v_and_b32 v81, s6, v111
    v_lshlrev_b32 v82, 16, v112
    v_and_b32 v83, s6, v112
    v_lshlrev_b32 v84, 16, v113
    v_and_b32 v85, s6, v113
    v_lshlrev_b32 v86, 16, v114
    v_and_b32 v87, s6, v114
    v_lshlrev_b32 v88, 16, v115
    v_and_b32 v89, s6, v115
    v_lshlrev_b32 v90, 16, v116
    v_and_b32 v91, s6, v116
    v_lshlrev_b32 v92, 16, v117
    v_and_b32 v93, s6, v117
    v_pk_mul_f32 v[94:95], v[62:63], v[48:49]
    v_pk_mul_f32 v[96:97], v[64:65], v[48:49]
    v_pk_mul_f32 v[98:99], v[66:67], v[48:49]
    v_pk_mul_f32 v[100:101], v[68:69], v[48:49]
    v_pk_mul_f32 v[102:103], v[70:71], v[48:49]
    v_pk_mul_f32 v[104:105], v[72:73], v[48:49]
    v_pk_mul_f32 v[106:107], v[74:75], v[48:49]
    v_pk_mul_f32 v[108:109], v[76:77], v[48:49]
    v_cvt_pk_bf16_f32 v110, v94, v95
    v_cvt_pk_bf16_f32 v111, v96, v97
    v_cvt_pk_bf16_f32 v112, v98, v99
    v_cvt_pk_bf16_f32 v113, v100, v101
    v_cvt_pk_bf16_f32 v114, v102, v103
    v_cvt_pk_bf16_f32 v115, v104, v105
    v_cvt_pk_bf16_f32 v116, v106, v107
    v_cvt_pk_bf16_f32 v117, v108, v109
    v_lshlrev_b32 v94, 16, v110
    v_and_b32 v95, s6, v110
    v_lshlrev_b32 v96, 16, v111
    v_and_b32 v97, s6, v111
    v_lshlrev_b32 v98, 16, v112
    v_and_b32 v99, s6, v112
    v_lshlrev_b32 v100, 16, v113
    v_and_b32 v101, s6, v113
    v_lshlrev_b32 v102, 16, v114
    v_and_b32 v103, s6, v114
    v_lshlrev_b32 v104, 16, v115
    v_and_b32 v105, s6, v115
    v_lshlrev_b32 v106, 16, v116
    v_and_b32 v107, s6, v116
    v_lshlrev_b32 v108, 16, v117
    v_and_b32 v109, s6, v117
    v_pk_add_f32 v[78:79], v[78:79], v[94:95]
    v_pk_add_f32 v[80:81], v[80:81], v[96:97]
    v_pk_add_f32 v[82:83], v[82:83], v[98:99]
    v_pk_add_f32 v[84:85], v[84:85], v[100:101]
    v_pk_add_f32 v[86:87], v[86:87], v[102:103]
    v_pk_add_f32 v[88:89], v[88:89], v[104:105]
    v_pk_add_f32 v[90:91], v[90:91], v[106:107]
    v_pk_add_f32 v[92:93], v[92:93], v[108:109]
    v_cvt_pk_bf16_f32 v110, v78, v79
    v_cvt_pk_bf16_f32 v111, v80, v81
    v_cvt_pk_bf16_f32 v112, v82, v83
    v_cvt_pk_bf16_f32 v113, v84, v85
    v_cvt_pk_bf16_f32 v114, v86, v87
    v_cvt_pk_bf16_f32 v115, v88, v89
    v_cvt_pk_bf16_f32 v116, v90, v91
    v_cvt_pk_bf16_f32 v117, v92, v93
    v_lshlrev_b32 v78, 16, v110
    v_and_b32 v79, s6, v110
    v_lshlrev_b32 v80, 16, v111
    v_and_b32 v81, s6, v111
    v_lshlrev_b32 v82, 16, v112
    v_and_b32 v83, s6, v112
    v_lshlrev_b32 v84, 16, v113
    v_and_b32 v85, s6, v113
    v_lshlrev_b32 v86, 16, v114
    v_and_b32 v87, s6, v114
    v_lshlrev_b32 v88, 16, v115
    v_and_b32 v89, s6, v115
    v_lshlrev_b32 v90, 16, v116
    v_and_b32 v91, s6, v116
    v_lshlrev_b32 v92, 16, v117
    v_and_b32 v93, s6, v117
    s_waitcnt vmcnt(8)
    v_lshlrev_b32 v94, 16, v20
    v_and_b32 v95, s6, v20
    v_lshlrev_b32 v96, 16, v21
    v_and_b32 v97, s6, v21
    v_lshlrev_b32 v98, 16, v22
    v_and_b32 v99, s6, v22
    v_lshlrev_b32 v100, 16, v23
    v_and_b32 v101, s6, v23
    v_lshlrev_b32 v102, 16, v24
    v_and_b32 v103, s6, v24
    v_lshlrev_b32 v104, 16, v25
    v_and_b32 v105, s6, v25
    v_lshlrev_b32 v106, 16, v26
    v_and_b32 v107, s6, v26
    v_lshlrev_b32 v108, 16, v27
    v_and_b32 v109, s6, v27
    v_pk_mul_f32 v[78:79], v[78:79], v[94:95]
    v_pk_mul_f32 v[80:81], v[80:81], v[96:97]
    v_pk_mul_f32 v[82:83], v[82:83], v[98:99]
    v_pk_mul_f32 v[84:85], v[84:85], v[100:101]
    v_pk_mul_f32 v[86:87], v[86:87], v[102:103]
    v_pk_mul_f32 v[88:89], v[88:89], v[104:105]
    v_pk_mul_f32 v[90:91], v[90:91], v[106:107]
    v_pk_mul_f32 v[92:93], v[92:93], v[108:109]
    v_cvt_pk_bf16_f32 v8, v92, v90
    v_cvt_pk_bf16_f32 v9, v88, v86
    v_cvt_pk_bf16_f32 v10, v84, v82
    v_cvt_pk_bf16_f32 v11, v80, v78
    v_cvt_pk_bf16_f32 v12, v93, v91
    v_cvt_pk_bf16_f32 v13, v89, v87
    v_cvt_pk_bf16_f32 v14, v85, v83
    v_cvt_pk_bf16_f32 v15, v81, v79
    ds_write_b128 v40, v[8:11]
    ds_write_b128 v40, v[12:15] offset:128
    s_mov_b32 s9, 84148480
    s_mov_b32 s10, 117834498
    s_waitcnt vmcnt(0)
    v_perm_b32 v20, v29, v28, s9
    v_perm_b32 v24, v29, v28, s10
    v_perm_b32 v21, v31, v30, s9
    v_perm_b32 v25, v31, v30, s10
    v_perm_b32 v22, v33, v32, s9
    v_perm_b32 v26, v33, v32, s10
    v_perm_b32 v23, v35, v34, s9
    v_perm_b32 v27, v35, v34, s10
    ds_write_b128 v40, v[20:23] offset:8192
    ds_write_b128 v40, v[24:27] offset:8320
    s_waitcnt lgkmcnt(0)
    s_barrier
    ds_read_b128 v[56:59], v41 offset:0
    ds_read_b128 v[60:63], v41 offset:4096
    ds_read_b128 v[64:67], v41 offset:8192
    ds_read_b128 v[68:71], v41 offset:12288
    s_add_u32 s8, s7, 0
    s_waitcnt lgkmcnt(3)
    buffer_store_dwordx4 v[56:59], v42, s[52:55], s8 offen
    s_add_u32 s8, s7, 131072
    s_waitcnt lgkmcnt(2)
    buffer_store_dwordx4 v[60:63], v42, s[52:55], s8 offen
    s_add_u32 s8, s7, 2097152
    s_waitcnt lgkmcnt(1)
    buffer_store_dwordx4 v[64:67], v42, s[52:55], s8 offen
    s_add_u32 s8, s7, 2228224
    s_waitcnt lgkmcnt(0)
    buffer_store_dwordx4 v[68:71], v42, s[52:55], s8 offen
    s_endpgm
L_B:
    s_sub_u32 s4, s4, 4
    s_cmp_ge_u32 s2, 84
    s_cbranch_scc1 L_B1_st
    s_lshr_b32 s3, s2, 1
    s_and_b32 s5, s2, 1
    s_mov_b32 s48, s38
    s_mov_b32 s49, s39
    s_mov_b32 s50, 2408448
    s_mov_b32 s51, 131072
    s_mov_b32 s64, s36
    s_mov_b32 s65, s37
    s_mov_b32 s66, 896
    s_mov_b32 s67, 131072
    s_lshl_b32 s13, s3, 7
    s_mul_i32 s12, s5, 1204224
    s_add_u32 s13, s13, s12
    s_mul_i32 s12, s5, 448
    v_subrev_u32 v7, 256, v0
    v_and_b32 v4, 7, v7
    v_lshrrev_b32 v2, 3, v7
    s_mov_b32 s7, 5376
    v_mul_lo_u32 v3, v2, s7
    v_lshl_add_u32 v3, v4, 4, v3
    v_lshlrev_b32 v92, 1, v2
    buffer_load_ushort v64, v92, s[64:67], s12 offen offset:0
    buffer_load_ushort v65, v92, s[64:67], s12 offen offset:64
    buffer_load_ushort v66, v92, s[64:67], s12 offen offset:128
    buffer_load_ushort v67, v92, s[64:67], s12 offen offset:192
    buffer_load_ushort v68, v92, s[64:67], s12 offen offset:256
    buffer_load_ushort v69, v92, s[64:67], s12 offen offset:320
    buffer_load_ushort v70, v92, s[64:67], s12 offen offset:384
    s_add_u32 s8, s13, 0
    buffer_load_dwordx4 v[8:11], v3, s[48:51], s8 offen nt
    s_add_u32 s8, s13, 172032
    buffer_load_dwordx4 v[12:15], v3, s[48:51], s8 offen nt
    s_add_u32 s8, s13, 344064
    buffer_load_dwordx4 v[16:19], v3, s[48:51], s8 offen nt
    s_add_u32 s8, s13, 516096
    buffer_load_dwordx4 v[20:23], v3, s[48:51], s8 offen nt
    s_add_u32 s8, s13, 688128
    buffer_load_dwordx4 v[24:27], v3, s[48:51], s8 offen nt
    s_add_u32 s8, s13, 860160
    buffer_load_dwordx4 v[28:31], v3, s[48:51], s8 offen nt
    s_add_u32 s8, s13, 1032192
    buffer_load_dwordx4 v[32:35], v3, s[48:51], s8 offen nt
    s_mov_b32 s9, 3216550459
    s_waitcnt vmcnt(7)
    v_lshlrev_b32 v64, 16, v64
    v_lshlrev_b32 v65, 16, v65
    v_lshlrev_b32 v66, 16, v66
    v_lshlrev_b32 v67, 16, v67
    v_lshlrev_b32 v68, 16, v68
    v_lshlrev_b32 v69, 16, v69
    v_lshlrev_b32 v70, 16, v70
    v_mul_f32 v78, s9, v64
    v_mul_f32 v79, s9, v65
    v_mul_f32 v80, s9, v66
    v_mul_f32 v81, s9, v67
    v_mul_f32 v82, s9, v68
    v_mul_f32 v83, s9, v69
    v_mul_f32 v84, s9, v70
    v_exp_f32 v78, v78
    v_exp_f32 v79, v79
    v_exp_f32 v80, v80
    v_exp_f32 v81, v81
    v_exp_f32 v82, v82
    v_exp_f32 v83, v83
    v_exp_f32 v84, v84
    v_add_f32 v78, 1.0, v78
    v_add_f32 v79, 1.0, v79
    v_add_f32 v80, 1.0, v80
    v_add_f32 v81, 1.0, v81
    v_add_f32 v82, 1.0, v82
    v_add_f32 v83, 1.0, v83
    v_add_f32 v84, 1.0, v84
    v_rcp_f32 v78, v78
    v_rcp_f32 v79, v79
    v_rcp_f32 v80, v80
    v_rcp_f32 v81, v81
    v_rcp_f32 v82, v82
    v_rcp_f32 v83, v83
    v_rcp_f32 v84, v84
    v_mul_f32 v64, v64, v78
    v_mul_f32 v65, v65, v79
    v_mul_f32 v66, v66, v80
    v_mul_f32 v67, v67, v81
    v_mul_f32 v68, v68, v82
    v_mul_f32 v69, v69, v83
    v_mul_f32 v70, v70, v84
    v_cvt_pk_bf16_f32 v64, v64, v64
    v_lshlrev_b32 v64, 16, v64
    v_cvt_pk_bf16_f32 v65, v65, v65
    v_lshlrev_b32 v65, 16, v65
    v_cvt_pk_bf16_f32 v66, v66, v66
    v_lshlrev_b32 v66, 16, v66
    v_cvt_pk_bf16_f32 v67, v67, v67
    v_lshlrev_b32 v67, 16, v67
    v_cvt_pk_bf16_f32 v68, v68, v68
    v_lshlrev_b32 v68, 16, v68
    v_cvt_pk_bf16_f32 v69, v69, v69
    v_lshlrev_b32 v69, 16, v69
    v_cvt_pk_bf16_f32 v70, v70, v70
    v_lshlrev_b32 v70, 16, v70
    v_mov_b32 v108, 0
    v_mov_b32 v109, 0
    v_mov_b32 v110, 0
    v_mov_b32 v111, 0
    v_mov_b32 v112, 0
    v_mov_b32 v113, 0
    v_mov_b32 v114, 0
    v_mov_b32 v115, 0
    s_waitcnt vmcnt(6)
    v_lshlrev_b32 v124, 16, v8
    v_and_b32 v125, s6, v8
    v_lshlrev_b32 v126, 16, v9
    v_and_b32 v127, s6, v9
    v_lshlrev_b32 v128, 16, v10
    v_and_b32 v129, s6, v10
    v_lshlrev_b32 v130, 16, v11
    v_and_b32 v131, s6, v11
    v_fmac_f32 v108, v64, v124
    v_fmac_f32 v109, v64, v125
    v_fmac_f32 v110, v64, v126
    v_fmac_f32 v111, v64, v127
    v_fmac_f32 v112, v64, v128
    v_fmac_f32 v113, v64, v129
    v_fmac_f32 v114, v64, v130
    v_fmac_f32 v115, v64, v131
    s_waitcnt vmcnt(5)
    v_lshlrev_b32 v132, 16, v12
    v_and_b32 v133, s6, v12
    v_lshlrev_b32 v134, 16, v13
    v_and_b32 v135, s6, v13
    v_lshlrev_b32 v136, 16, v14
    v_and_b32 v137, s6, v14
    v_lshlrev_b32 v138, 16, v15
    v_and_b32 v139, s6, v15
    v_fmac_f32 v108, v65, v132
    v_fmac_f32 v109, v65, v133
    v_fmac_f32 v110, v65, v134
    v_fmac_f32 v111, v65, v135
    v_fmac_f32 v112, v65, v136
    v_fmac_f32 v113, v65, v137
    v_fmac_f32 v114, v65, v138
    v_fmac_f32 v115, v65, v139
    s_waitcnt vmcnt(4)
    v_lshlrev_b32 v124, 16, v16
    v_and_b32 v125, s6, v16
    v_lshlrev_b32 v126, 16, v17
    v_and_b32 v127, s6, v17
    v_lshlrev_b32 v128, 16, v18
    v_and_b32 v129, s6, v18
    v_lshlrev_b32 v130, 16, v19
    v_and_b32 v131, s6, v19
    v_fmac_f32 v108, v66, v124
    v_fmac_f32 v109, v66, v125
    v_fmac_f32 v110, v66, v126
    v_fmac_f32 v111, v66, v127
    v_fmac_f32 v112, v66, v128
    v_fmac_f32 v113, v66, v129
    v_fmac_f32 v114, v66, v130
    v_fmac_f32 v115, v66, v131
    s_waitcnt vmcnt(3)
    v_lshlrev_b32 v132, 16, v20
    v_and_b32 v133, s6, v20
    v_lshlrev_b32 v134, 16, v21
    v_and_b32 v135, s6, v21
    v_lshlrev_b32 v136, 16, v22
    v_and_b32 v137, s6, v22
    v_lshlrev_b32 v138, 16, v23
    v_and_b32 v139, s6, v23
    v_fmac_f32 v108, v67, v132
    v_fmac_f32 v109, v67, v133
    v_fmac_f32 v110, v67, v134
    v_fmac_f32 v111, v67, v135
    v_fmac_f32 v112, v67, v136
    v_fmac_f32 v113, v67, v137
    v_fmac_f32 v114, v67, v138
    v_fmac_f32 v115, v67, v139
    s_waitcnt vmcnt(2)
    v_lshlrev_b32 v124, 16, v24
    v_and_b32 v125, s6, v24
    v_lshlrev_b32 v126, 16, v25
    v_and_b32 v127, s6, v25
    v_lshlrev_b32 v128, 16, v26
    v_and_b32 v129, s6, v26
    v_lshlrev_b32 v130, 16, v27
    v_and_b32 v131, s6, v27
    v_fmac_f32 v108, v68, v124
    v_fmac_f32 v109, v68, v125
    v_fmac_f32 v110, v68, v126
    v_fmac_f32 v111, v68, v127
    v_fmac_f32 v112, v68, v128
    v_fmac_f32 v113, v68, v129
    v_fmac_f32 v114, v68, v130
    v_fmac_f32 v115, v68, v131
    s_waitcnt vmcnt(1)
    v_lshlrev_b32 v132, 16, v28
    v_and_b32 v133, s6, v28
    v_lshlrev_b32 v134, 16, v29
    v_and_b32 v135, s6, v29
    v_lshlrev_b32 v136, 16, v30
    v_and_b32 v137, s6, v30
    v_lshlrev_b32 v138, 16, v31
    v_and_b32 v139, s6, v31
    v_fmac_f32 v108, v69, v132
    v_fmac_f32 v109, v69, v133
    v_fmac_f32 v110, v69, v134
    v_fmac_f32 v111, v69, v135
    v_fmac_f32 v112, v69, v136
    v_fmac_f32 v113, v69, v137
    v_fmac_f32 v114, v69, v138
    v_fmac_f32 v115, v69, v139
    s_waitcnt vmcnt(0)
    v_lshlrev_b32 v124, 16, v32
    v_and_b32 v125, s6, v32
    v_lshlrev_b32 v126, 16, v33
    v_and_b32 v127, s6, v33
    v_lshlrev_b32 v128, 16, v34
    v_and_b32 v129, s6, v34
    v_lshlrev_b32 v130, 16, v35
    v_and_b32 v131, s6, v35
    v_fmac_f32 v108, v70, v124
    v_fmac_f32 v109, v70, v125
    v_fmac_f32 v110, v70, v126
    v_fmac_f32 v111, v70, v127
    v_fmac_f32 v112, v70, v128
    v_fmac_f32 v113, v70, v129
    v_fmac_f32 v114, v70, v130
    v_fmac_f32 v115, v70, v131
    v_add_f32_dpp v108, v108, v108 row_ror:8 row_mask:0xf bank_mask:0xf
    v_add_f32_dpp v109, v109, v109 row_ror:8 row_mask:0xf bank_mask:0xf
    v_add_f32_dpp v110, v110, v110 row_ror:8 row_mask:0xf bank_mask:0xf
    v_add_f32_dpp v111, v111, v111 row_ror:8 row_mask:0xf bank_mask:0xf
    v_add_f32_dpp v112, v112, v112 row_ror:8 row_mask:0xf bank_mask:0xf
    v_add_f32_dpp v113, v113, v113 row_ror:8 row_mask:0xf bank_mask:0xf
    v_add_f32_dpp v114, v114, v114 row_ror:8 row_mask:0xf bank_mask:0xf
    v_add_f32_dpp v115, v115, v115 row_ror:8 row_mask:0xf bank_mask:0xf
    v_mov_b32 v8, v108
    v_mov_b32 v9, v109
    v_mov_b32 v10, v110
    v_mov_b32 v11, v111
    v_mov_b32 v12, v112
    v_mov_b32 v13, v113
    v_mov_b32 v14, v114
    v_mov_b32 v15, v115
    v_permlane16_swap_b32 v8, v108
    v_permlane16_swap_b32 v9, v109
    v_permlane16_swap_b32 v10, v110
    v_permlane16_swap_b32 v11, v111
    v_permlane16_swap_b32 v12, v112
    v_permlane16_swap_b32 v13, v113
    v_permlane16_swap_b32 v14, v114
    v_permlane16_swap_b32 v15, v115
    v_add_f32 v108, v108, v8
    v_add_f32 v109, v109, v9
    v_add_f32 v110, v110, v10
    v_add_f32 v111, v111, v11
    v_add_f32 v112, v112, v12
    v_add_f32 v113, v113, v13
    v_add_f32 v114, v114, v14
    v_add_f32 v115, v115, v15
    v_mov_b32 v8, v108
    v_mov_b32 v9, v109
    v_mov_b32 v10, v110
    v_mov_b32 v11, v111
    v_mov_b32 v12, v112
    v_mov_b32 v13, v113
    v_mov_b32 v14, v114
    v_mov_b32 v15, v115
    v_permlane32_swap_b32 v8, v108
    v_permlane32_swap_b32 v9, v109
    v_permlane32_swap_b32 v10, v110
    v_permlane32_swap_b32 v11, v111
    v_permlane32_swap_b32 v12, v112
    v_permlane32_swap_b32 v13, v113
    v_permlane32_swap_b32 v14, v114
    v_permlane32_swap_b32 v15, v115
    v_add_f32 v108, v108, v8
    v_add_f32 v109, v109, v9
    v_add_f32 v110, v110, v10
    v_add_f32 v111, v111, v11
    v_add_f32 v112, v112, v12
    v_add_f32 v113, v113, v13
    v_add_f32 v114, v114, v14
    v_add_f32 v115, v115, v15
    s_lshl_b32 s8, s4, 8
    s_add_u32 s8, s8, 16384
    v_lshl_add_u32 v5, v4, 5, s8
    v_cmp_gt_u32 vcc, 8, v1
    s_nop 1
    s_and_saveexec_b64 s[10:11], vcc
    ds_write_b128 v5, v[108:111]
    ds_write_b128 v5, v[112:115] offset:16
    s_mov_b64 exec, s[10:11]
    s_waitcnt lgkmcnt(0)
    s_barrier
    s_cmp_lg_u32 s4, 0
    s_cbranch_scc1 L_B1_done
    v_lshlrev_b32 v5, 2, v1
    v_add_u32 v6, 16384, v5
    ds_read_b32 v8, v6 offset:0
    ds_read_b32 v9, v6 offset:256
    ds_read_b32 v10, v6 offset:512
    ds_read_b32 v11, v6 offset:768
    s_waitcnt lgkmcnt(0)
    v_add_f32 v8, v8, v9
    v_add_f32 v10, v10, v11
    v_add_f32 v8, v8, v10
    s_lshl_b32 s8, s3, 8
    s_mul_i32 s12, s5, 10752
    s_add_u32 s8, s8, s12
    s_add_u32 s8, s8, 6356992
    buffer_store_dword v8, v5, s[52:55], s8 offen
    s_branch L_B1_done
L_B1_st:
    s_sub_u32 s3, s2, 84
    s_cmp_ge_u32 s3, 128
    s_cbranch_scc1 L_B1_none
    s_mul_i32 s5, s4, 3584
    v_mov_b32 v5, s5
    v_lshl_add_u32 v5, v1, 4, v5
    s_mul_i32 s5, s3, 14336
    v_cmp_gt_u32 s[14:15], 56, v1
    s_mov_b64 s[10:11], exec
    s_mov_b32 s48, s16
    s_mov_b32 s49, s17
    s_mov_b32 s50, 1835008
    s_mov_b32 s51, 131072
    v_mov_b32 v24, 0
    v_mov_b32 v32, 0
    v_mov_b32 v25, 0
    v_mov_b32 v33, 0
    v_mov_b32 v26, 0
    v_mov_b32 v34, 0
    v_mov_b32 v27, 0
    v_mov_b32 v35, 0
    s_mov_b32 s7, 1065369472
    s_mov_b64 exec, s[14:15]
    buffer_load_dwordx4 v[8:11], v5, s[48:51], s5 offen offset:0
    buffer_load_dwordx4 v[12:15], v5, s[48:51], s5 offen offset:896
    buffer_load_dwordx4 v[16:19], v5, s[48:51], s5 offen offset:1792
    buffer_load_dwordx4 v[20:23], v5, s[48:51], s5 offen offset:2688
    s_mov_b64 exec, s[10:11]
    s_mov_b64 exec, s[14:15]
    s_waitcnt vmcnt(3)
    v_dot2_f32_bf16 v24, v8, s7, v24
    v_dot2_f32_bf16 v24, v9, s7, v24
    v_dot2_f32_bf16 v24, v10, s7, v24
    v_dot2_f32_bf16 v24, v11, s7, v24
    s_waitcnt vmcnt(2)
    v_dot2_f32_bf16 v25, v12, s7, v25
    v_dot2_f32_bf16 v25, v13, s7, v25
    v_dot2_f32_bf16 v25, v14, s7, v25
    v_dot2_f32_bf16 v25, v15, s7, v25
    s_waitcnt vmcnt(1)
    v_dot2_f32_bf16 v26, v16, s7, v26
    v_dot2_f32_bf16 v26, v17, s7, v26
    v_dot2_f32_bf16 v26, v18, s7, v26
    v_dot2_f32_bf16 v26, v19, s7, v26
    s_waitcnt vmcnt(0)
    v_dot2_f32_bf16 v27, v20, s7, v27
    v_dot2_f32_bf16 v27, v21, s7, v27
    v_dot2_f32_bf16 v27, v22, s7, v27
    v_dot2_f32_bf16 v27, v23, s7, v27
    s_mov_b64 exec, s[10:11]
    v_add_f32_dpp v24, v24, v24 quad_perm:[1,0,3,2] row_mask:0xf bank_mask:0xf
    v_add_f32_dpp v25, v25, v25 quad_perm:[1,0,3,2] row_mask:0xf bank_mask:0xf
    v_add_f32_dpp v26, v26, v26 quad_perm:[1,0,3,2] row_mask:0xf bank_mask:0xf
    v_add_f32_dpp v27, v27, v27 quad_perm:[1,0,3,2] row_mask:0xf bank_mask:0xf
    v_add_f32_dpp v24, v24, v24 quad_perm:[2,3,0,1] row_mask:0xf bank_mask:0xf
    v_add_f32_dpp v25, v25, v25 quad_perm:[2,3,0,1] row_mask:0xf bank_mask:0xf
    v_add_f32_dpp v26, v26, v26 quad_perm:[2,3,0,1] row_mask:0xf bank_mask:0xf
    v_add_f32_dpp v27, v27, v27 quad_perm:[2,3,0,1] row_mask:0xf bank_mask:0xf
    v_add_f32_dpp v24, v24, v24 row_half_mirror row_mask:0xf bank_mask:0xf
    v_add_f32_dpp v25, v25, v25 row_half_mirror row_mask:0xf bank_mask:0xf
    v_add_f32_dpp v26, v26, v26 row_half_mirror row_mask:0xf bank_mask:0xf
    v_add_f32_dpp v27, v27, v27 row_half_mirror row_mask:0xf bank_mask:0xf
    v_add_f32_dpp v24, v24, v24 row_mirror row_mask:0xf bank_mask:0xf
    v_add_f32_dpp v25, v25, v25 row_mirror row_mask:0xf bank_mask:0xf
    v_add_f32_dpp v26, v26, v26 row_mirror row_mask:0xf bank_mask:0xf
    v_add_f32_dpp v27, v27, v27 row_mirror row_mask:0xf bank_mask:0xf
    v_mov_b32 v28, v24
    v_mov_b32 v29, v25
    v_mov_b32 v30, v26
    v_mov_b32 v31, v27
    v_permlane16_swap_b32 v28, v24
    v_permlane16_swap_b32 v29, v25
    v_permlane16_swap_b32 v30, v26
    v_permlane16_swap_b32 v31, v27
    v_add_f32 v24, v24, v28
    v_add_f32 v25, v25, v29
    v_add_f32 v26, v26, v30
    v_add_f32 v27, v27, v31
    v_mov_b32 v28, v24
    v_mov_b32 v29, v25
    v_mov_b32 v30, v26
    v_mov_b32 v31, v27
    v_permlane32_swap_b32 v28, v24
    v_permlane32_swap_b32 v29, v25
    v_permlane32_swap_b32 v30, v26
    v_permlane32_swap_b32 v31, v27
    v_add_f32 v24, v24, v28
    v_add_f32 v25, v25, v29
    v_add_f32 v26, v26, v30
    v_add_f32 v27, v27, v31
    s_mov_b32 s8, 991054117
    v_mul_f32 v24, s8, v24
    v_mul_f32 v25, s8, v25
    v_mul_f32 v26, s8, v26
    v_mul_f32 v27, s8, v27
    s_mov_b64 exec, s[14:15]
    v_lshlrev_b32 v40, 16, v8
    v_and_b32 v41, s6, v8
    v_lshlrev_b32 v42, 16, v9
    v_and_b32 v43, s6, v9
    v_lshlrev_b32 v44, 16, v10
    v_and_b32 v45, s6, v10
    v_lshlrev_b32 v46, 16, v11
    v_and_b32 v47, s6, v11
    v_sub_f32 v40, v40, v24
    v_sub_f32 v41, v41, v24
    v_sub_f32 v42, v42, v24
    v_sub_f32 v43, v43, v24
    v_sub_f32 v44, v44, v24
    v_sub_f32 v45, v45, v24
    v_sub_f32 v46, v46, v24
    v_sub_f32 v47, v47, v24
    v_lshlrev_b32 v48, 16, v12
    v_and_b32 v49, s6, v12
    v_lshlrev_b32 v50, 16, v13
    v_and_b32 v51, s6, v13
    v_lshlrev_b32 v52, 16, v14
    v_and_b32 v53, s6, v14
    v_lshlrev_b32 v54, 16, v15
    v_and_b32 v55, s6, v15
    v_sub_f32 v48, v48, v25
    v_sub_f32 v49, v49, v25
    v_sub_f32 v50, v50, v25
    v_sub_f32 v51, v51, v25
    v_sub_f32 v52, v52, v25
    v_sub_f32 v53, v53, v25
    v_sub_f32 v54, v54, v25
    v_sub_f32 v55, v55, v25
    v_lshlrev_b32 v56, 16, v16
    v_and_b32 v57, s6, v16
    v_lshlrev_b32 v58, 16, v17
    v_and_b32 v59, s6, v17
    v_lshlrev_b32 v60, 16, v18
    v_and_b32 v61, s6, v18
    v_lshlrev_b32 v62, 16, v19
    v_and_b32 v63, s6, v19
    v_sub_f32 v56, v56, v26
    v_sub_f32 v57, v57, v26
    v_sub_f32 v58, v58, v26
    v_sub_f32 v59, v59, v26
    v_sub_f32 v60, v60, v26
    v_sub_f32 v61, v61, v26
    v_sub_f32 v62, v62, v26
    v_sub_f32 v63, v63, v26
    v_lshlrev_b32 v64, 16, v20
    v_and_b32 v65, s6, v20
    v_lshlrev_b32 v66, 16, v21
    v_and_b32 v67, s6, v21
    v_lshlrev_b32 v68, 16, v22
    v_and_b32 v69, s6, v22
    v_lshlrev_b32 v70, 16, v23
    v_and_b32 v71, s6, v23
    v_sub_f32 v64, v64, v27
    v_sub_f32 v65, v65, v27
    v_sub_f32 v66, v66, v27
    v_sub_f32 v67, v67, v27
    v_sub_f32 v68, v68, v27
    v_sub_f32 v69, v69, v27
    v_sub_f32 v70, v70, v27
    v_sub_f32 v71, v71, v27
    v_fmac_f32 v32, v40, v40
    v_fmac_f32 v33, v48, v48
    v_fmac_f32 v34, v56, v56
    v_fmac_f32 v35, v64, v64
    v_fmac_f32 v32, v41, v41
    v_fmac_f32 v33, v49, v49
    v_fmac_f32 v34, v57, v57
    v_fmac_f32 v35, v65, v65
    v_fmac_f32 v32, v42, v42
    v_fmac_f32 v33, v50, v50
    v_fmac_f32 v34, v58, v58
    v_fmac_f32 v35, v66, v66
    v_fmac_f32 v32, v43, v43
    v_fmac_f32 v33, v51, v51
    v_fmac_f32 v34, v59, v59
    v_fmac_f32 v35, v67, v67
    v_fmac_f32 v32, v44, v44
    v_fmac_f32 v33, v52, v52
    v_fmac_f32 v34, v60, v60
    v_fmac_f32 v35, v68, v68
    v_fmac_f32 v32, v45, v45
    v_fmac_f32 v33, v53, v53
    v_fmac_f32 v34, v61, v61
    v_fmac_f32 v35, v69, v69
    v_fmac_f32 v32, v46, v46
    v_fmac_f32 v33, v54, v54
    v_fmac_f32 v34, v62, v62
    v_fmac_f32 v35, v70, v70
    v_fmac_f32 v32, v47, v47
    v_fmac_f32 v33, v55, v55
    v_fmac_f32 v34, v63, v63
    v_fmac_f32 v35, v71, v71
    s_mov_b64 exec, s[10:11]
    v_add_f32_dpp v32, v32, v32 quad_perm:[1,0,3,2] row_mask:0xf bank_mask:0xf
    v_add_f32_dpp v33, v33, v33 quad_perm:[1,0,3,2] row_mask:0xf bank_mask:0xf
    v_add_f32_dpp v34, v34, v34 quad_perm:[1,0,3,2] row_mask:0xf bank_mask:0xf
    v_add_f32_dpp v35, v35, v35 quad_perm:[1,0,3,2] row_mask:0xf bank_mask:0xf
    v_add_f32_dpp v32, v32, v32 quad_perm:[2,3,0,1] row_mask:0xf bank_mask:0xf
    v_add_f32_dpp v33, v33, v33 quad_perm:[2,3,0,1] row_mask:0xf bank_mask:0xf
    v_add_f32_dpp v34, v34, v34 quad_perm:[2,3,0,1] row_mask:0xf bank_mask:0xf
    v_add_f32_dpp v35, v35, v35 quad_perm:[2,3,0,1] row_mask:0xf bank_mask:0xf
    v_add_f32_dpp v32, v32, v32 row_half_mirror row_mask:0xf bank_mask:0xf
    v_add_f32_dpp v33, v33, v33 row_half_mirror row_mask:0xf bank_mask:0xf
    v_add_f32_dpp v34, v34, v34 row_half_mirror row_mask:0xf bank_mask:0xf
    v_add_f32_dpp v35, v35, v35 row_half_mirror row_mask:0xf bank_mask:0xf
    v_add_f32_dpp v32, v32, v32 row_mirror row_mask:0xf bank_mask:0xf
    v_add_f32_dpp v33, v33, v33 row_mirror row_mask:0xf bank_mask:0xf
    v_add_f32_dpp v34, v34, v34 row_mirror row_mask:0xf bank_mask:0xf
    v_add_f32_dpp v35, v35, v35 row_mirror row_mask:0xf bank_mask:0xf
    v_mov_b32 v28, v32
    v_mov_b32 v29, v33
    v_mov_b32 v30, v34
    v_mov_b32 v31, v35
    v_permlane16_swap_b32 v28, v32
    v_permlane16_swap_b32 v29, v33
    v_permlane16_swap_b32 v30, v34
    v_permlane16_swap_b32 v31, v35
    v_add_f32 v32, v32, v28
    v_add_f32 v33, v33, v29
    v_add_f32 v34, v34, v30
    v_add_f32 v35, v35, v31
    v_mov_b32 v28, v32
    v_mov_b32 v29, v33
    v_mov_b32 v30, v34
    v_mov_b32 v31, v35
    v_permlane32_swap_b32 v28, v32
    v_permlane32_swap_b32 v29, v33
    v_permlane32_swap_b32 v30, v34
    v_permlane32_swap_b32 v31, v35
    v_add_f32 v32, v32, v28
    v_add_f32 v33, v33, v29
    v_add_f32 v34, v34, v30
    v_add_f32 v35, v35, v31
    s_mov_b32 s9, 925353388
    v_mul_f32 v32, s8, v32
    v_mul_f32 v33, s8, v33
    v_mul_f32 v34, s8, v34
    v_mul_f32 v35, s8, v35
    v_cvt_pk_bf16_f32 v32, v32, v32
    v_lshlrev_b32 v32, 16, v32
    v_cvt_pk_bf16_f32 v33, v33, v33
    v_lshlrev_b32 v33, 16, v33
    v_cvt_pk_bf16_f32 v34, v34, v34
    v_lshlrev_b32 v34, 16, v34
    v_cvt_pk_bf16_f32 v35, v35, v35
    v_lshlrev_b32 v35, 16, v35
    v_add_f32 v32, s9, v32
    v_add_f32 v33, s9, v33
    v_add_f32 v34, s9, v34
    v_add_f32 v35, s9, v35
    v_cvt_pk_bf16_f32 v32, v32, v32
    v_lshlrev_b32 v32, 16, v32
    v_cvt_pk_bf16_f32 v33, v33, v33
    v_lshlrev_b32 v33, 16, v33
    v_cvt_pk_bf16_f32 v34, v34, v34
    v_lshlrev_b32 v34, 16, v34
    v_cvt_pk_bf16_f32 v35, v35, v35
    v_lshlrev_b32 v35, 16, v35
    v_sqrt_f32 v32, v32
    v_sqrt_f32 v33, v33
    v_sqrt_f32 v34, v34
    v_sqrt_f32 v35, v35
    v_cvt_pk_bf16_f32 v36, v24, v32
    v_cvt_pk_bf16_f32 v37, v25, v33
    v_cvt_pk_bf16_f32 v38, v26, v34
    v_cvt_pk_bf16_f32 v39, v27, v35
    s_lshl_b32 s5, s3, 6
    s_lshl_b32 s7, s4, 4
    s_add_u32 s5, s5, s7
    s_add_u32 s5, s5, 6291456
    v_lshlrev_b32 v2, 28, v1
    v_lshl_add_u32 v2, v1, 25, v2
    buffer_store_dwordx4 v[36:39], v2, s[52:55], s5 offen
    s_barrier
    s_branch L_B1_done
L_B1_none:
    s_barrier
L_B1_done:
    s_endpgm
.section .rodata,"a"
.p2align 6
.amdhsa_kernel k1_kernel
  .amdhsa_next_free_vgpr 140
  .amdhsa_next_free_sgpr 68
  .amdhsa_accum_offset 140
  .amdhsa_group_segment_fixed_size 0
  .amdhsa_kernarg_size 120
  .amdhsa_user_sgpr_count 2
  .amdhsa_user_sgpr_kernarg_segment_ptr 1
  .amdhsa_system_sgpr_workgroup_id_x 1
.end_amdhsa_kernel
.text
.globl k2_kernel
.p2align 8
.type k2_kernel,@function
k2_kernel:
    s_load_dwordx16 s[16:31], s[0:1], 0
    s_load_dwordx8 s[32:39], s[0:1], 64
    s_load_dwordx4 s[40:43], s[0:1], 96
    s_load_dwordx2 s[44:45], s[0:1], 112
    s_cmp_ge_u32 s2, 224
    s_cbranch_scc1 L_k2_exit
    s_mov_b32 s6, 4294901760
    s_and_b32 s3, s2, 7
    s_mul_i32 s3, s3, 28
    s_lshr_b32 s4, s2, 3
    s_add_u32 s3, s3, s4
    v_and_b32 v1, 63, v0
    v_lshrrev_b32 v2, 6, v0
    s_nop 0
    v_readfirstlane_b32 s4, v2
    s_lshl_b32 s9, s3, 3
    s_add_u32 s9, s9, 6356992
    v_mov_b32 v54, 86528
    v_mov_b32 v55, 0
    ds_write_b32 v54, v55
    ds_write_b32 v54, v55 offset:4
    ds_write_b32 v54, v55 offset:8
    ds_write_b32 v54, v55 offset:12
    s_waitcnt lgkmcnt(0)
    s_barrier
    s_cmp_ge_u32 s4, 4
    s_cbranch_scc1 L_k2_side
    s_lshr_b32 s5, s4, 1
    s_and_b32 s7, s4, 1
    s_lshl_b32 s8, s3, 1
    s_add_u32 s8, s8, s5
    s_lshl_b32 s10, s8, 12
    s_lshl_b32 s12, s7, 11
    v_lshl_add_u32 v3, v1, 4, s12
    v_and_b32 v32, 15, v1
    v_lshlrev_b32 v32, 6, v32
    v_lshrrev_b32 v33, 4, v1
    v_lshl_add_u32 v32, v33, 4, v32
    s_add_u32 s13, s12, s10
    s_mul_i32 s14, s5, 6144
    s_add_u32 s14, s14, 33280
    s_add_u32 s15, s12, s14
    s_lshl_b32 s11, s3, 13
    s_add_u32 s11, s11, 2101248
    v_lshlrev_b32 v6, 4, v0
    s_waitcnt lgkmcnt(0)
    s_mov_b32 s48, s24
    s_mov_b32 s49, s25
    s_mov_b32 s50, 1835008
    s_mov_b32 s51, 131072
    s_mov_b32 s52, s44
    s_mov_b32 s53, s45
    s_mov_b32 s54, 22577152
    s_mov_b32 s55, 131072
    buffer_load_dwordx4 v[88:91], v3, s[48:51], s10 offen offset:0 nt
    buffer_load_dwordx2 v[92:93], v3, s[48:51], s10 offen offset:16 nt
    buffer_load_dwordx4 v[94:97], v3, s[48:51], s10 offen offset:1024 nt
    buffer_load_dwordx2 v[98:99], v3, s[48:51], s10 offen offset:1040 nt
    s_add_u32 m0, s15, 2048
    s_add_u32 s70, s13, 0
    buffer_load_dwordx4 v32, s[52:55], s70 offen lds
    s_add_u32 m0, s15, 3072
    s_add_u32 s70, s13, 1024
    buffer_load_dwordx4 v32, s[52:55], s70 offen lds
    v_lshlrev_b32 v7, 5, v0
    s_mov_b32 s71, 6291456
    buffer_load_dwordx4 v[8:11], v6, s[52:55], s11 offen
    buffer_load_dwordx4 v[16:19], v7, s[52:55], s71 offen offset:0
    buffer_load_dwordx4 v[20:23], v7, s[52:55], s71 offen offset:16
    s_add_u32 s98, s44, s9
    s_addc_u32 s99, s45, 0
    s_load_dword s60, s[98:99], 4
    s_load_dword s63, s[98:99], 10756
    s_load_dword s61, s[98:99], 1796
    s_load_dword s64, s[98:99], 12548
    s_load_dword s62, s[98:99], 3588
    s_load_dword s65, s[98:99], 14340
    s_lshl_b32 s9, s3, 2
    s_add_u32 s58, s26, s9
    s_addc_u32 s59, s27, 0
    s_load_dword s66, s[58:59], 0
    s_mul_i32 s15, s5, 16640
    v_mov_b32 v36, 0
    v_mov_b32 v37, 0
    v_mov_b32 v38, 0
    v_mov_b32 v39, 0
    s_lshl_b32 s12, s7, 10
    s_add_u32 s12, s12, s14
    v_lshl_add_u32 v35, v1, 4, s12
    ds_write_b128 v35, v[36:39]
    v_bfe_u32 v40, v1, 2, 2
    v_mul_u32_u24 v40, 4160, v40
    v_and_b32 v41, 3, v1
    v_lshl_add_u32 v40, v41, 4, v40
    v_add_u32 v40, s15, v40
    s_lshl_b32 s13, s7, 4
    s_sub_u32 s13, 16, s13
    v_cmp_gt_u32 vcc, s13, v1
    s_nop 1
    s_and_saveexec_b64 s[68:69], vcc
    ds_write_b128 v40, v[36:39]
    s_mov_b64 exec, s[68:69]
    v_and_b32 v44, 31, v1
    v_lshrrev_b32 v45, 5, v1
    v_add_u32 v46, 1, v44
    v_and_b32 v42, 3, v46
    v_mul_u32_u24 v42, 4160, v42
    v_and_b32 v46, 60, v46
    v_lshl_add_u32 v42, v46, 1, v42
    v_lshlrev_b32 v46, 4, v45
    v_sub_u32 v42, v42, v46
    s_lshl_b32 s13, s7, 10
    s_add_u32 s12, s15, s13
    s_add_u32 s12, s12, 16
    v_add_u32 v42, s12, v42
    s_lshl_b32 s12, s7, 4
    s_sub_u32 s12, 32, s12
    v_lshl_add_u32 v43, v45, 8, s14
    v_add_u32 v48, s12, v44
    v_subrev_u32 v46, 0, v48
    v_and_b32 v24, 15, v46
    v_lshl_add_u32 v24, v24, 4, v43
    v_lshrrev_b32 v46, 4, v46
    v_lshl_add_u32 v24, v46, 10, v24
    v_subrev_u32 v46, 1, v48
    v_and_b32 v25, 15, v46
    v_lshl_add_u32 v25, v25, 4, v43
    v_lshrrev_b32 v46, 4, v46
    v_lshl_add_u32 v25, v46, 10, v25
    v_subrev_u32 v46, 2, v48
    v_and_b32 v26, 15, v46
    v_lshl_add_u32 v26, v26, 4, v43
    v_lshrrev_b32 v46, 4, v46
    v_lshl_add_u32 v26, v46, 10, v26
    v_mul_u32_u24 v47, 144, v44
    v_lshl_add_u32 v47, v45, 4, v47
    s_mul_i32 s12, s4, 9216
    s_add_u32 s12, s12, 45568
    v_add_u32 v47, s12, v47
    v_and_b32 v49, 3, v0
    v_lshlrev_b32 v49, 8, v49
    v_bfe_u32 v46, v0, 2, 4
    v_lshl_add_u32 v49, v46, 4, v49
    v_lshrrev_b32 v46, 6, v0
    v_lshl_add_u32 v49, v46, 10, v49
    v_lshrrev_b32 v120, 2, v0
    v_lshlrev_b32 v120, 4, v120
    v_lshl_add_u32 v120, v0, 5, v120
    v_add_u32 v120, 45568, v120
    v_lshlrev_b32 v121, 4, v0
    s_mul_i32 s12, s3, 8704
    s_add_u32 s12, s12, 4198656
    v_add_u32 v34, s15, v3
    v_lshlrev_b32 v40, 4, v1
    v_sub_u32 v40, 48, v40
    v_mul_u32_u24 v35, 4160, v1
    v_add_u32 v35, s15, v35
    s_lshl_b32 s13, s7, 2
    s_sub_u32 s13, 4, s13
    v_cmp_gt_u32 s[72:73], s13, v1
    s_waitcnt vmcnt(7)
    ds_write_b128 v34, v[88:91] offset:64
    v_alignbit_b32 v100, v89, v88, 16
    v_alignbit_b32 v101, v90, v89, 16
    v_alignbit_b32 v102, v91, v90, 16
    v_alignbit_b32 v103, v92, v91, 16
    v_alignbit_b32 v104, v93, v92, 16
    ds_write_b128 v34, v[100:103] offset:4224
    v_mov_b32 v112, v89
    v_mov_b32 v113, v90
    v_mov_b32 v114, v91
    v_mov_b32 v115, v92
    ds_write_b128 v34, v[112:115] offset:8384
    v_mov_b32 v116, v101
    v_mov_b32 v117, v102
    v_mov_b32 v118, v103
    v_mov_b32 v119, v104
    ds_write_b128 v34, v[116:119] offset:12544
    s_waitcnt vmcnt(5)
    ds_write_b128 v34, v[94:97] offset:1088
    v_alignbit_b32 v106, v95, v94, 16
    v_alignbit_b32 v107, v96, v95, 16
    v_alignbit_b32 v108, v97, v96, 16
    v_alignbit_b32 v109, v98, v97, 16
    v_alignbit_b32 v110, v99, v98, 16
    ds_write_b128 v34, v[106:109] offset:5248
    v_mov_b32 v112, v95
    v_mov_b32 v113, v96
    v_mov_b32 v114, v97
    v_mov_b32 v115, v98
    ds_write_b128 v34, v[112:115] offset:9408
    v_mov_b32 v116, v107
    v_mov_b32 v117, v108
    v_mov_b32 v118, v109
    v_mov_b32 v119, v110
    ds_write_b128 v34, v[116:119] offset:13568
    v_readfirstlane_b32 s70, v88
    v_readfirstlane_b32 s71, v89
    s_nop 0
    v_mov_b32 v4, s70
    v_mov_b32 v5, s71
    v_lshlrev_b64 v[4:5], v40, v[4:5]
    v_lshlrev_b64 v[4:5], 16, v[4:5]
    s_mov_b64 exec, s[72:73]
    ds_write_b64 v35, v[4:5] offset:56
    s_mov_b64 exec, s[68:69]
    s_waitcnt lgkmcnt(0)
    v_mov_b32 v50, s61
    v_mov_b32 v51, s60
    v_mov_b32 v12, s62
    v_add_f32 v50, s64, v50
    v_add_f32 v51, s63, v51
    v_add_f32 v12, s65, v12
    v_cvt_pk_bf16_f32 v53, v50, v51
    v_lshlrev_b32 v50, 16, v53
    v_and_b32 v51, s6, v53
    v_cvt_pk_bf16_f32 v12, v12, v12
    v_lshlrev_b32 v12, 16, v12
    v_mov_b32 v13, v12
    v_add_f32 v50, 1.0, v50
    v_cvt_pk_bf16_f32 v50, v50, v50
    v_lshlrev_b32 v50, 16, v50
    v_mov_b32 v52, s66
    v_and_b32 v52, s6, v52
    s_waitcnt vmcnt(3)
    s_lshl_b32 s70, s4, 2
    v_add_u32 v53, s70, v54
    v_mov_b32 v55, 1
    ds_write_b32 v53, v55
L_k2_fwc:
    ds_read_b128 v[56:59], v54
    s_waitcnt lgkmcnt(0)
    v_and_b32 v56, v56, v57
    v_and_b32 v58, v58, v59
    v_and_b32 v56, v56, v58
    s_nop 0
    v_readfirstlane_b32 s70, v56
    s_nop 1
    s_cmp_eq_u32 s70, 0
    s_cbranch_scc1 L_k2_fwc
    ds_read_b128 v[188:191], v49 offset:41472
    ds_read_b64 v[88:89], v42 offset:32
    ds_read_b64 v[90:91], v42 offset:40
    ds_read_b128 v[56:59], v24 offset:0
    ds_read_b128 v[64:67], v24 offset:2048
    ds_read_b64 v[96:97], v42 offset:2080
    ds_read_b64 v[98:99], v42 offset:2088
    ds_read_b64 v[92:93], v42 offset:0
    ds_read_b64 v[94:95], v42 offset:8
    ds_read_b128 v[60:63], v24 offset:512
    ds_read_b128 v[68:71], v24 offset:2560
    ds_read_b64 v[100:101], v42 offset:2048
    ds_read_b64 v[102:103], v42 offset:2056
    s_waitcnt vmcnt(0)
    s_waitcnt lgkmcnt(9)
    v_mfma_f32_32x32x16_bf16 a[0:15], v[88:91], v[56:59], 0
    ds_read_b64 v[104:105], v42 offset:96
    ds_read_b64 v[106:107], v42 offset:104
    v_lshlrev_b32 v144, 16, v8
    v_and_b32 v145, s6, v8
    s_waitcnt lgkmcnt(10)
    v_mfma_f32_32x32x16_bf16 a[16:31], v[88:91], v[64:67], 0
    ds_read_b128 v[72:75], v25 offset:0
    ds_read_b128 v[80:83], v25 offset:2048
    v_lshlrev_b32 v146, 16, v9
    v_and_b32 v147, s6, v9
    s_waitcnt lgkmcnt(10)
    v_mfma_f32_32x32x16_bf16 a[16:31], v[96:99], v[56:59], a[16:31]
    ds_read_b64 v[112:113], v42 offset:2144
    ds_read_b64 v[114:115], v42 offset:2152
    v_lshlrev_b32 v148, 16, v10
    v_and_b32 v149, s6, v10
    s_waitcnt lgkmcnt(9)
    v_mfma_f32_32x32x16_bf16 a[0:15], v[92:95], v[60:63], a[0:15]
    ds_read_b64 v[108:109], v42 offset:64
    ds_read_b64 v[110:111], v42 offset:72
    v_lshlrev_b32 v150, 16, v11
    v_and_b32 v151, s6, v11
    s_waitcnt lgkmcnt(10)
    v_mfma_f32_32x32x16_bf16 a[16:31], v[92:95], v[68:71], a[16:31]
    ds_read_b128 v[76:79], v25 offset:512
    ds_read_b128 v[84:87], v25 offset:2560
    v_and_b32 v176, s6, v16
    v_lshlrev_b32 v168, 16, v16
    s_waitcnt lgkmcnt(10)
    v_mfma_f32_32x32x16_bf16 a[16:31], v[100:103], v[60:63], a[16:31]
    ds_read_b64 v[116:117], v42 offset:2112
    ds_read_b64 v[118:119], v42 offset:2120
    v_subrev_u32 v46, 3, v48
    v_and_b32 v27, 15, v46
    v_lshl_add_u32 v27, v27, 4, v43
    v_lshrrev_b32 v46, 4, v46
    v_lshl_add_u32 v27, v46, 10, v27
    s_waitcnt lgkmcnt(9)
    v_mfma_f32_32x32x16_bf16 a[0:15], v[104:107], v[72:75], a[0:15]
    ds_read_b64 v[88:89], v42 offset:160
    ds_read_b64 v[90:91], v42 offset:168
    v_and_b32 v177, s6, v17
    v_lshlrev_b32 v169, 16, v17
    s_waitcnt lgkmcnt(10)
    v_mfma_f32_32x32x16_bf16 a[16:31], v[104:107], v[80:83], a[16:31]
    ds_read_b128 v[56:59], v26 offset:0
    ds_read_b128 v[64:67], v26 offset:2048
    v_and_b32 v178, s6, v18
    v_lshlrev_b32 v170, 16, v18
    s_waitcnt lgkmcnt(10)
    v_mfma_f32_32x32x16_bf16 a[16:31], v[112:115], v[72:75], a[16:31]
    ds_read_b64 v[96:97], v42 offset:2208
    ds_read_b64 v[98:99], v42 offset:2216
    v_and_b32 v179, s6, v19
    v_lshlrev_b32 v171, 16, v19
    s_waitcnt lgkmcnt(9)
    v_mfma_f32_32x32x16_bf16 a[0:15], v[108:111], v[76:79], a[0:15]
    ds_read_b64 v[92:93], v42 offset:128
    ds_read_b64 v[94:95], v42 offset:136
    v_and_b32 v180, s6, v20
    v_lshlrev_b32 v172, 16, v20
    s_waitcnt lgkmcnt(10)
    v_mfma_f32_32x32x16_bf16 a[16:31], v[108:111], v[84:87], a[16:31]
    ds_read_b128 v[60:63], v26 offset:512
    ds_read_b128 v[68:71], v26 offset:2560
    v_and_b32 v181, s6, v21
    v_lshlrev_b32 v173, 16, v21
    s_waitcnt lgkmcnt(10)
    v_mfma_f32_32x32x16_bf16 a[16:31], v[116:119], v[76:79], a[16:31]
    ds_read_b64 v[100:101], v42 offset:2176
    ds_read_b64 v[102:103], v42 offset:2184
    v_subrev_u32 v46, 4, v48
    v_and_b32 v24, 15, v46
    v_lshl_add_u32 v24, v24, 4, v43
    v_lshrrev_b32 v46, 4, v46
    v_lshl_add_u32 v24, v46, 10, v24
    s_waitcnt lgkmcnt(9)
    v_mfma_f32_32x32x16_bf16 a[0:15], v[88:91], v[56:59], a[0:15]
    ds_read_b64 v[104:105], v42 offset:224
    ds_read_b64 v[106:107], v42 offset:232
    v_and_b32 v182, s6, v22
    v_lshlrev_b32 v174, 16, v22
    s_waitcnt lgkmcnt(10)
    v_mfma_f32_32x32x16_bf16 a[16:31], v[88:91], v[64:67], a[16:31]
    ds_read_b128 v[72:75], v27 offset:0
    ds_read_b128 v[80:83], v27 offset:2048
    v_and_b32 v183, s6, v23
    v_lshlrev_b32 v175, 16, v23
    s_waitcnt lgkmcnt(10)
    v_mfma_f32_32x32x16_bf16 a[16:31], v[96:99], v[56:59], a[16:31]
    ds_read_b64 v[112:113], v42 offset:2272
    ds_read_b64 v[114:115], v42 offset:2280
    v_rcp_f32 v176, v176
    v_sub_f32 v152, v144, v168
    s_waitcnt lgkmcnt(9)
    v_mfma_f32_32x32x16_bf16 a[0:15], v[92:95], v[60:63], a[0:15]
    ds_read_b64 v[108:109], v42 offset:192
    ds_read_b64 v[110:111], v42 offset:200
    v_rcp_f32 v177, v177
    v_sub_f32 v153, v145, v169
    s_waitcnt lgkmcnt(10)
    v_mfma_f32_32x32x16_bf16 a[16:31], v[92:95], v[68:71], a[16:31]
    ds_read_b128 v[76:79], v27 offset:512
    ds_read_b128 v[84:87], v27 offset:2560
    v_rcp_f32 v178, v178
    v_sub_f32 v154, v146, v170
    s_waitcnt lgkmcnt(10)
    v_mfma_f32_32x32x16_bf16 a[16:31], v[100:103], v[60:63], a[16:31]
    ds_read_b64 v[116:117], v42 offset:2240
    ds_read_b64 v[118:119], v42 offset:2248
    v_subrev_u32 v46, 5, v48
    v_and_b32 v25, 15, v46
    v_lshl_add_u32 v25, v25, 4, v43
    v_lshrrev_b32 v46, 4, v46
    v_lshl_add_u32 v25, v46, 10, v25
    s_waitcnt lgkmcnt(9)
    v_mfma_f32_32x32x16_bf16 a[0:15], v[104:107], v[72:75], a[0:15]
    ds_read_b64 v[88:89], v42 offset:288
    ds_read_b64 v[90:91], v42 offset:296
    v_rcp_f32 v179, v179
    v_sub_f32 v155, v147, v171
    s_waitcnt lgkmcnt(10)
    v_mfma_f32_32x32x16_bf16 a[16:31], v[104:107], v[80:83], a[16:31]
    ds_read_b128 v[56:59], v24 offset:0
    ds_read_b128 v[64:67], v24 offset:2048
    v_rcp_f32 v180, v180
    v_sub_f32 v156, v148, v172
    s_waitcnt lgkmcnt(10)
    v_mfma_f32_32x32x16_bf16 a[16:31], v[112:115], v[72:75], a[16:31]
    ds_read_b64 v[96:97], v42 offset:2336
    ds_read_b64 v[98:99], v42 offset:2344
    v_rcp_f32 v181, v181
    v_sub_f32 v157, v149, v173
    s_waitcnt lgkmcnt(9)
    v_mfma_f32_32x32x16_bf16 a[0:15], v[108:111], v[76:79], a[0:15]
    ds_read_b64 v[92:93], v42 offset:256
    ds_read_b64 v[94:95], v42 offset:264
    v_rcp_f32 v182, v182
    v_sub_f32 v158, v150, v174
    s_waitcnt lgkmcnt(10)
    v_mfma_f32_32x32x16_bf16 a[16:31], v[108:111], v[84:87], a[16:31]
    ds_read_b128 v[60:63], v24 offset:512
    ds_read_b128 v[68:71], v24 offset:2560
    v_rcp_f32 v183, v183
    v_sub_f32 v159, v151, v175
    s_waitcnt lgkmcnt(10)
    v_mfma_f32_32x32x16_bf16 a[16:31], v[116:119], v[76:79], a[16:31]
    ds_read_b64 v[100:101], v42 offset:2304
    ds_read_b64 v[102:103], v42 offset:2312
    v_subrev_u32 v46, 6, v48
    v_and_b32 v26, 15, v46
    v_lshl_add_u32 v26, v26, 4, v43
    v_lshrrev_b32 v46, 4, v46
    v_lshl_add_u32 v26, v46, 10, v26
    s_waitcnt lgkmcnt(9)
    v_mfma_f32_32x32x16_bf16 a[0:15], v[88:91], v[56:59], a[0:15]
    ds_read_b64 v[104:105], v42 offset:352
    ds_read_b64 v[106:107], v42 offset:360
    v_cvt_pk_bf16_f32 v184, v152, v153
    v_cvt_pk_bf16_f32 v185, v154, v155
    s_waitcnt lgkmcnt(10)
    v_mfma_f32_32x32x16_bf16 a[16:31], v[88:91], v[64:67], a[16:31]
    ds_read_b128 v[72:75], v25 offset:0
    ds_read_b128 v[80:83], v25 offset:2048
    v_cvt_pk_bf16_f32 v186, v156, v157
    v_cvt_pk_bf16_f32 v187, v158, v159
    s_waitcnt lgkmcnt(10)
    v_mfma_f32_32x32x16_bf16 a[16:31], v[96:99], v[56:59], a[16:31]
    ds_read_b64 v[112:113], v42 offset:2400
    ds_read_b64 v[114:115], v42 offset:2408
    v_lshlrev_b32 v152, 16, v184
    v_and_b32 v153, s6, v184
    s_waitcnt lgkmcnt(9)
    v_mfma_f32_32x32x16_bf16 a[0:15], v[92:95], v[60:63], a[0:15]
    ds_read_b64 v[108:109], v42 offset:320
    ds_read_b64 v[110:111], v42 offset:328
    v_lshlrev_b32 v154, 16, v185
    v_and_b32 v155, s6, v185
    s_waitcnt lgkmcnt(10)
    v_mfma_f32_32x32x16_bf16 a[16:31], v[92:95], v[68:71], a[16:31]
    ds_read_b128 v[76:79], v25 offset:512
    ds_read_b128 v[84:87], v25 offset:2560
    v_lshlrev_b32 v156, 16, v186
    v_and_b32 v157, s6, v186
    s_waitcnt lgkmcnt(10)
    v_mfma_f32_32x32x16_bf16 a[16:31], v[100:103], v[60:63], a[16:31]
    ds_read_b64 v[116:117], v42 offset:2368
    ds_read_b64 v[118:119], v42 offset:2376
    v_subrev_u32 v46, 7, v48
    v_and_b32 v27, 15, v46
    v_lshl_add_u32 v27, v27, 4, v43
    v_lshrrev_b32 v46, 4, v46
    v_lshl_add_u32 v27, v46, 10, v27
    s_waitcnt lgkmcnt(9)
    v_mfma_f32_32x32x16_bf16 a[0:15], v[104:107], v[72:75], a[0:15]
    ds_read_b64 v[88:89], v42 offset:416
    ds_read_b64 v[90:91], v42 offset:424
    v_lshlrev_b32 v158, 16, v187
    v_and_b32 v159, s6, v187
    s_waitcnt lgkmcnt(10)
    v_mfma_f32_32x32x16_bf16 a[16:31], v[104:107], v[80:83], a[16:31]
    ds_read_b128 v[56:59], v26 offset:0
    ds_read_b128 v[64:67], v26 offset:2048
    v_mul_f32 v152, v152, v176
    v_mul_f32 v153, v153, v177
    s_waitcnt lgkmcnt(10)
    v_mfma_f32_32x32x16_bf16 a[16:31], v[112:115], v[72:75], a[16:31]
    ds_read_b64 v[96:97], v42 offset:2464
    ds_read_b64 v[98:99], v42 offset:2472
    v_mul_f32 v154, v154, v178
    v_mul_f32 v155, v155, v179
    s_waitcnt lgkmcnt(9)
    v_mfma_f32_32x32x16_bf16 a[0:15], v[108:111], v[76:79], a[0:15]
    ds_read_b64 v[92:93], v42 offset:384
    ds_read_b64 v[94:95], v42 offset:392
    v_mul_f32 v156, v156, v180
    v_mul_f32 v157, v157, v181
    s_waitcnt lgkmcnt(10)
    v_mfma_f32_32x32x16_bf16 a[16:31], v[108:111], v[84:87], a[16:31]
    ds_read_b128 v[60:63], v26 offset:512
    ds_read_b128 v[68:71], v26 offset:2560
    v_mul_f32 v158, v158, v182
    v_mul_f32 v159, v159, v183
    s_waitcnt lgkmcnt(10)
    v_mfma_f32_32x32x16_bf16 a[16:31], v[116:119], v[76:79], a[16:31]
    ds_read_b64 v[100:101], v42 offset:2432
    ds_read_b64 v[102:103], v42 offset:2440
    v_subrev_u32 v46, 8, v48
    v_and_b32 v24, 15, v46
    v_lshl_add_u32 v24, v24, 4, v43
    v_lshrrev_b32 v46, 4, v46
    v_lshl_add_u32 v24, v46, 10, v24
    s_waitcnt lgkmcnt(9)
    v_mfma_f32_32x32x16_bf16 a[0:15], v[88:91], v[56:59], a[0:15]
    ds_read_b64 v[104:105], v42 offset:480
    ds_read_b64 v[106:107], v42 offset:488
    v_cvt_pk_bf16_f32 v184, v152, v153
    v_cvt_pk_bf16_f32 v185, v154, v155
    s_waitcnt lgkmcnt(10)
    v_mfma_f32_32x32x16_bf16 a[16:31], v[88:91], v[64:67], a[16:31]
    ds_read_b128 v[72:75], v27 offset:0
    ds_read_b128 v[80:83], v27 offset:2048
    v_cvt_pk_bf16_f32 v186, v156, v157
    v_cvt_pk_bf16_f32 v187, v158, v159
    s_waitcnt lgkmcnt(10)
    v_mfma_f32_32x32x16_bf16 a[16:31], v[96:99], v[56:59], a[16:31]
    ds_read_b64 v[112:113], v42 offset:2528
    ds_read_b64 v[114:115], v42 offset:2536
    v_lshlrev_b32 v152, 16, v184
    v_and_b32 v153, s6, v184
    s_waitcnt lgkmcnt(9)
    v_mfma_f32_32x32x16_bf16 a[0:15], v[92:95], v[60:63], a[0:15]
    ds_read_b64 v[108:109], v42 offset:448
    ds_read_b64 v[110:111], v42 offset:456
    v_lshlrev_b32 v154, 16, v185
    v_and_b32 v155, s6, v185
    s_waitcnt lgkmcnt(10)
    v_mfma_f32_32x32x16_bf16 a[16:31], v[92:95], v[68:71], a[16:31]
    ds_read_b128 v[76:79], v27 offset:512
    ds_read_b128 v[84:87], v27 offset:2560
    v_lshlrev_b32 v156, 16, v186
    v_and_b32 v157, s6, v186
    s_waitcnt lgkmcnt(10)
    v_mfma_f32_32x32x16_bf16 a[16:31], v[100:103], v[60:63], a[16:31]
    ds_read_b64 v[116:117], v42 offset:2496
    ds_read_b64 v[118:119], v42 offset:2504
    v_subrev_u32 v46, 9, v48
    v_and_b32 v25, 15, v46
    v_lshl_add_u32 v25, v25, 4, v43
    v_lshrrev_b32 v46, 4, v46
    v_lshl_add_u32 v25, v46, 10, v25
    s_waitcnt lgkmcnt(9)
    v_mfma_f32_32x32x16_bf16 a[0:15], v[104:107], v[72:75], a[0:15]
    ds_read_b64 v[88:89], v42 offset:544
    ds_read_b64 v[90:91], v42 offset:552
    v_lshlrev_b32 v158, 16, v187
    v_and_b32 v159, s6, v187
    s_waitcnt lgkmcnt(10)
    v_mfma_f32_32x32x16_bf16 a[16:31], v[104:107], v[80:83], a[16:31]
    ds_read_b128 v[56:59], v24 offset:0
    ds_read_b128 v[64:67], v24 offset:2048
    v_mul_f32 v152, v152, v50
    v_mul_f32 v153, v153, v50
    s_waitcnt lgkmcnt(10)
    v_mfma_f32_32x32x16_bf16 a[16:31], v[112:115], v[72:75], a[16:31]
    ds_read_b64 v[96:97], v42 offset:2592
    ds_read_b64 v[98:99], v42 offset:2600
    v_mul_f32 v154, v154, v50
    v_mul_f32 v155, v155, v50
    s_waitcnt lgkmcnt(9)
    v_mfma_f32_32x32x16_bf16 a[0:15], v[108:111], v[76:79], a[0:15]
    ds_read_b64 v[92:93], v42 offset:512
    ds_read_b64 v[94:95], v42 offset:520
    v_mul_f32 v156, v156, v50
    v_mul_f32 v157, v157, v50
    s_waitcnt lgkmcnt(10)
    v_mfma_f32_32x32x16_bf16 a[16:31], v[108:111], v[84:87], a[16:31]
    ds_read_b128 v[60:63], v24 offset:512
    ds_read_b128 v[68:71], v24 offset:2560
    v_mul_f32 v158, v158, v50
    v_mul_f32 v159, v159, v50
    s_waitcnt lgkmcnt(10)
    v_mfma_f32_32x32x16_bf16 a[16:31], v[116:119], v[76:79], a[16:31]
    ds_read_b64 v[100:101], v42 offset:2560
    ds_read_b64 v[102:103], v42 offset:2568
    v_subrev_u32 v46, 10, v48
    v_and_b32 v26, 15, v46
    v_lshl_add_u32 v26, v26, 4, v43
    v_lshrrev_b32 v46, 4, v46
    v_lshl_add_u32 v26, v46, 10, v26
    s_waitcnt lgkmcnt(9)
    v_mfma_f32_32x32x16_bf16 a[0:15], v[88:91], v[56:59], a[0:15]
    ds_read_b64 v[104:105], v42 offset:608
    ds_read_b64 v[106:107], v42 offset:616
    v_cvt_pk_bf16_f32 v184, v152, v153
    v_cvt_pk_bf16_f32 v185, v154, v155
    s_waitcnt lgkmcnt(10)
    v_mfma_f32_32x32x16_bf16 a[16:31], v[88:91], v[64:67], a[16:31]
    ds_read_b128 v[72:75], v25 offset:0
    ds_read_b128 v[80:83], v25 offset:2048
    v_cvt_pk_bf16_f32 v186, v156, v157
    v_cvt_pk_bf16_f32 v187, v158, v159
    s_waitcnt lgkmcnt(10)
    v_mfma_f32_32x32x16_bf16 a[16:31], v[96:99], v[56:59], a[16:31]
    ds_read_b64 v[112:113], v42 offset:2656
    ds_read_b64 v[114:115], v42 offset:2664
    v_lshlrev_b32 v152, 16, v184
    v_and_b32 v153, s6, v184
    s_waitcnt lgkmcnt(9)
    v_mfma_f32_32x32x16_bf16 a[0:15], v[92:95], v[60:63], a[0:15]
    ds_read_b64 v[108:109], v42 offset:576
    ds_read_b64 v[110:111], v42 offset:584
    v_lshlrev_b32 v154, 16, v185
    v_and_b32 v155, s6, v185
    s_waitcnt lgkmcnt(10)
    v_mfma_f32_32x32x16_bf16 a[16:31], v[92:95], v[68:71], a[16:31]
    ds_read_b128 v[76:79], v25 offset:512
    ds_read_b128 v[84:87], v25 offset:2560
    v_lshlrev_b32 v156, 16, v186
    v_and_b32 v157, s6, v186
    s_waitcnt lgkmcnt(10)
    v_mfma_f32_32x32x16_bf16 a[16:31], v[100:103], v[60:63], a[16:31]
    ds_read_b64 v[116:117], v42 offset:2624
    ds_read_b64 v[118:119], v42 offset:2632
    v_subrev_u32 v46, 11, v48
    v_and_b32 v27, 15, v46
    v_lshl_add_u32 v27, v27, 4, v43
    v_lshrrev_b32 v46, 4, v46
    v_lshl_add_u32 v27, v46, 10, v27
    s_waitcnt lgkmcnt(9)
    v_mfma_f32_32x32x16_bf16 a[0:15], v[104:107], v[72:75], a[0:15]
    ds_read_b64 v[88:89], v42 offset:672
    ds_read_b64 v[90:91], v42 offset:680
    v_lshlrev_b32 v158, 16, v187
    v_and_b32 v159, s6, v187
    s_waitcnt lgkmcnt(10)
    v_mfma_f32_32x32x16_bf16 a[16:31], v[104:107], v[80:83], a[16:31]
    ds_read_b128 v[56:59], v26 offset:0
    ds_read_b128 v[64:67], v26 offset:2048
    v_add_f32 v152, v152, v51
    v_add_f32 v153, v153, v51
    s_waitcnt lgkmcnt(10)
    v_mfma_f32_32x32x16_bf16 a[16:31], v[112:115], v[72:75], a[16:31]
    ds_read_b64 v[96:97], v42 offset:2720
    ds_read_b64 v[98:99], v42 offset:2728
    v_add_f32 v154, v154, v51
    v_add_f32 v155, v155, v51
    s_waitcnt lgkmcnt(9)
    v_mfma_f32_32x32x16_bf16 a[0:15], v[108:111], v[76:79], a[0:15]
    ds_read_b64 v[92:93], v42 offset:640
    ds_read_b64 v[94:95], v42 offset:648
    v_add_f32 v156, v156, v51
    v_add_f32 v157, v157, v51
    s_waitcnt lgkmcnt(10)
    v_mfma_f32_32x32x16_bf16 a[16:31], v[108:111], v[84:87], a[16:31]
    ds_read_b128 v[60:63], v26 offset:512
    ds_read_b128 v[68:71], v26 offset:2560
    v_add_f32 v158, v158, v51
    v_add_f32 v159, v159, v51
    s_waitcnt lgkmcnt(10)
    v_mfma_f32_32x32x16_bf16 a[16:31], v[116:119], v[76:79], a[16:31]
    ds_read_b64 v[100:101], v42 offset:2688
    ds_read_b64 v[102:103], v42 offset:2696
    v_subrev_u32 v46, 12, v48
    v_and_b32 v24, 15, v46
    v_lshl_add_u32 v24, v24, 4, v43
    v_lshrrev_b32 v46, 4, v46
    v_lshl_add_u32 v24, v46, 10, v24
    s_waitcnt lgkmcnt(9)
    v_mfma_f32_32x32x16_bf16 a[0:15], v[88:91], v[56:59], a[0:15]
    ds_read_b64 v[104:105], v42 offset:736
    ds_read_b64 v[106:107], v42 offset:744
    v_cvt_pk_bf16_f32 v184, v152, v153
    v_cvt_pk_bf16_f32 v185, v154, v155
    s_waitcnt lgkmcnt(10)
    v_mfma_f32_32x32x16_bf16 a[16:31], v[88:91], v[64:67], a[16:31]
    ds_read_b128 v[72:75], v27 offset:0
    ds_read_b128 v[80:83], v27 offset:2048
    v_cvt_pk_bf16_f32 v186, v156, v157
    v_cvt_pk_bf16_f32 v187, v158, v159
    s_waitcnt lgkmcnt(10)
    v_mfma_f32_32x32x16_bf16 a[16:31], v[96:99], v[56:59], a[16:31]
    ds_read_b64 v[112:113], v42 offset:2784
    ds_read_b64 v[114:115], v42 offset:2792
    v_lshlrev_b32 v152, 16, v184
    v_and_b32 v153, s6, v184
    s_waitcnt lgkmcnt(9)
    v_mfma_f32_32x32x16_bf16 a[0:15], v[92:95], v[60:63], a[0:15]
    ds_read_b64 v[108:109], v42 offset:704
    ds_read_b64 v[110:111], v42 offset:712
    v_lshlrev_b32 v154, 16, v185
    v_and_b32 v155, s6, v185
    s_waitcnt lgkmcnt(10)
    v_mfma_f32_32x32x16_bf16 a[16:31], v[92:95], v[68:71], a[16:31]
    ds_read_b128 v[76:79], v27 offset:512
    ds_read_b128 v[84:87], v27 offset:2560
    v_lshlrev_b32 v156, 16, v186
    v_and_b32 v157, s6, v186
    s_waitcnt lgkmcnt(10)
    v_mfma_f32_32x32x16_bf16 a[16:31], v[100:103], v[60:63], a[16:31]
    ds_read_b64 v[116:117], v42 offset:2752
    ds_read_b64 v[118:119], v42 offset:2760
    v_subrev_u32 v46, 13, v48
    v_and_b32 v25, 15, v46
    v_lshl_add_u32 v25, v25, 4, v43
    v_lshrrev_b32 v46, 4, v46
    v_lshl_add_u32 v25, v46, 10, v25
    s_waitcnt lgkmcnt(9)
    v_mfma_f32_32x32x16_bf16 a[0:15], v[104:107], v[72:75], a[0:15]
    ds_read_b64 v[88:89], v42 offset:800
    ds_read_b64 v[90:91], v42 offset:808
    v_lshlrev_b32 v158, 16, v187
    v_and_b32 v159, s6, v187
    s_waitcnt lgkmcnt(10)
    v_mfma_f32_32x32x16_bf16 a[16:31], v[104:107], v[80:83], a[16:31]
    ds_read_b128 v[56:59], v24 offset:0
    ds_read_b128 v[64:67], v24 offset:2048
    v_lshlrev_b32 v167, 16, v188
    s_waitcnt lgkmcnt(10)
    v_mfma_f32_32x32x16_bf16 a[16:31], v[112:115], v[72:75], a[16:31]
    ds_read_b64 v[96:97], v42 offset:2848
    ds_read_b64 v[98:99], v42 offset:2856
    v_and_b32 v166, s6, v188
    v_lshlrev_b32 v165, 16, v189
    s_waitcnt lgkmcnt(9)
    v_mfma_f32_32x32x16_bf16 a[0:15], v[108:111], v[76:79], a[0:15]
    ds_read_b64 v[92:93], v42 offset:768
    ds_read_b64 v[94:95], v42 offset:776
    v_and_b32 v164, s6, v189
    v_lshlrev_b32 v163, 16, v190
    s_waitcnt lgkmcnt(10)
    v_mfma_f32_32x32x16_bf16 a[16:31], v[108:111], v[84:87], a[16:31]
    ds_read_b128 v[60:63], v24 offset:512
    ds_read_b128 v[68:71], v24 offset:2560
    v_and_b32 v162, s6, v190
    v_lshlrev_b32 v161, 16, v191
    s_waitcnt lgkmcnt(10)
    v_mfma_f32_32x32x16_bf16 a[16:31], v[116:119], v[76:79], a[16:31]
    ds_read_b64 v[100:101], v42 offset:2816
    ds_read_b64 v[102:103], v42 offset:2824
    v_subrev_u32 v46, 14, v48
    v_and_b32 v26, 15, v46
    v_lshl_add_u32 v26, v26, 4, v43
    v_lshrrev_b32 v46, 4, v46
    v_lshl_add_u32 v26, v46, 10, v26
    s_waitcnt lgkmcnt(9)
    v_mfma_f32_32x32x16_bf16 a[0:15], v[88:91], v[56:59], a[0:15]
    ds_read_b64 v[104:105], v42 offset:864
    ds_read_b64 v[106:107], v42 offset:872
    v_and_b32 v160, s6, v191
    v_mul_f32 v160, v160, v52
    s_waitcnt lgkmcnt(10)
    v_mfma_f32_32x32x16_bf16 a[16:31], v[88:91], v[64:67], a[16:31]
    ds_read_b128 v[72:75], v25 offset:0
    ds_read_b128 v[80:83], v25 offset:2048
    v_mul_f32 v161, v161, v52
    v_mul_f32 v162, v162, v52
    s_waitcnt lgkmcnt(10)
    v_mfma_f32_32x32x16_bf16 a[16:31], v[96:99], v[56:59], a[16:31]
    ds_read_b64 v[112:113], v42 offset:2912
    ds_read_b64 v[114:115], v42 offset:2920
    v_mul_f32 v163, v163, v52
    v_mul_f32 v164, v164, v52
    s_waitcnt lgkmcnt(9)
    v_mfma_f32_32x32x16_bf16 a[0:15], v[92:95], v[60:63], a[0:15]
    ds_read_b64 v[108:109], v42 offset:832
    ds_read_b64 v[110:111], v42 offset:840
    v_mul_f32 v165, v165, v52
    v_mul_f32 v166, v166, v52
    s_waitcnt lgkmcnt(10)
    v_mfma_f32_32x32x16_bf16 a[16:31], v[92:95], v[68:71], a[16:31]
    ds_read_b128 v[76:79], v25 offset:512
    ds_read_b128 v[84:87], v25 offset:2560
    v_mul_f32 v167, v167, v52
    v_cvt_pk_bf16_f32 v184, v160, v161
    s_waitcnt lgkmcnt(10)
    v_mfma_f32_32x32x16_bf16 a[16:31], v[100:103], v[60:63], a[16:31]
    ds_read_b64 v[116:117], v42 offset:2880
    ds_read_b64 v[118:119], v42 offset:2888
    v_subrev_u32 v46, 15, v48
    v_and_b32 v27, 15, v46
    v_lshl_add_u32 v27, v27, 4, v43
    v_lshrrev_b32 v46, 4, v46
    v_lshl_add_u32 v27, v46, 10, v27
    s_waitcnt lgkmcnt(9)
    v_mfma_f32_32x32x16_bf16 a[0:15], v[104:107], v[72:75], a[0:15]
    ds_read_b64 v[88:89], v42 offset:928
    ds_read_b64 v[90:91], v42 offset:936
    v_cvt_pk_bf16_f32 v185, v162, v163
    v_cvt_pk_bf16_f32 v186, v164, v165
    s_waitcnt lgkmcnt(10)
    v_mfma_f32_32x32x16_bf16 a[16:31], v[104:107], v[80:83], a[16:31]
    ds_read_b128 v[56:59], v26 offset:0
    ds_read_b128 v[64:67], v26 offset:2048
    v_cvt_pk_bf16_f32 v187, v166, v167
    v_lshlrev_b32 v160, 16, v184
    s_waitcnt lgkmcnt(10)
    v_mfma_f32_32x32x16_bf16 a[16:31], v[112:115], v[72:75], a[16:31]
    ds_read_b64 v[96:97], v42 offset:2976
    ds_read_b64 v[98:99], v42 offset:2984
    v_and_b32 v161, s6, v184
    v_lshlrev_b32 v162, 16, v185
    s_waitcnt lgkmcnt(9)
    v_mfma_f32_32x32x16_bf16 a[0:15], v[108:111], v[76:79], a[0:15]
    ds_read_b64 v[92:93], v42 offset:896
    ds_read_b64 v[94:95], v42 offset:904
    v_and_b32 v163, s6, v185
    v_lshlrev_b32 v164, 16, v186
    s_waitcnt lgkmcnt(10)
    v_mfma_f32_32x32x16_bf16 a[16:31], v[108:111], v[84:87], a[16:31]
    ds_read_b128 v[60:63], v26 offset:512
    ds_read_b128 v[68:71], v26 offset:2560
    v_and_b32 v165, s6, v186
    v_lshlrev_b32 v166, 16, v187
    s_waitcnt lgkmcnt(10)
    v_mfma_f32_32x32x16_bf16 a[16:31], v[116:119], v[76:79], a[16:31]
    ds_read_b64 v[100:101], v42 offset:2944
    ds_read_b64 v[102:103], v42 offset:2952
    v_and_b32 v167, s6, v187
    s_waitcnt lgkmcnt(9)
    v_mfma_f32_32x32x16_bf16 a[0:15], v[88:91], v[56:59], a[0:15]
    ds_read_b64 v[104:105], v42 offset:992
    ds_read_b64 v[106:107], v42 offset:1000
    s_waitcnt lgkmcnt(10)
    v_mfma_f32_32x32x16_bf16 a[16:31], v[88:91], v[64:67], a[16:31]
    ds_read_b128 v[72:75], v27 offset:0
    ds_read_b128 v[80:83], v27 offset:2048
    s_waitcnt lgkmcnt(10)
    v_mfma_f32_32x32x16_bf16 a[16:31], v[96:99], v[56:59], a[16:31]
    ds_read_b64 v[112:113], v42 offset:3040
    ds_read_b64 v[114:115], v42 offset:3048
    s_waitcnt lgkmcnt(9)
    v_mfma_f32_32x32x16_bf16 a[0:15], v[92:95], v[60:63], a[0:15]
    ds_read_b64 v[108:109], v42 offset:960
    ds_read_b64 v[110:111], v42 offset:968
    s_waitcnt lgkmcnt(10)
    v_mfma_f32_32x32x16_bf16 a[16:31], v[92:95], v[68:71], a[16:31]
    ds_read_b128 v[76:79], v27 offset:512
    ds_read_b128 v[84:87], v27 offset:2560
    s_waitcnt lgkmcnt(10)
    v_mfma_f32_32x32x16_bf16 a[16:31], v[100:103], v[60:63], a[16:31]
    ds_read_b64 v[116:117], v42 offset:3008
    ds_read_b64 v[118:119], v42 offset:3016
    s_waitcnt lgkmcnt(9)
    v_mfma_f32_32x32x16_bf16 a[0:15], v[104:107], v[72:75], a[0:15]
    s_waitcnt lgkmcnt(8)
    v_mfma_f32_32x32x16_bf16 a[16:31], v[104:107], v[80:83], a[16:31]
    s_waitcnt lgkmcnt(6)
    v_mfma_f32_32x32x16_bf16 a[16:31], v[112:115], v[72:75], a[16:31]
    s_waitcnt lgkmcnt(3)
    v_mfma_f32_32x32x16_bf16 a[0:15], v[108:111], v[76:79], a[0:15]
    s_waitcnt lgkmcnt(2)
    v_mfma_f32_32x32x16_bf16 a[16:31], v[108:111], v[84:87], a[16:31]
    s_waitcnt lgkmcnt(0)
    v_mfma_f32_32x32x16_bf16 a[16:31], v[116:119], v[76:79], a[16:31]
    s_nop 7
    ds_write_b128 v47, a[0:3] offset:0
    ds_write_b128 v47, a[4:7] offset:32
    ds_write_b128 v47, a[8:11] offset:64
    ds_write_b128 v47, a[12:15] offset:96
    ds_write_b128 v47, a[16:19] offset:4608
    ds_write_b128 v47, a[20:23] offset:4640
    ds_write_b128 v47, a[24:27] offset:4672
    ds_write_b128 v47, a[28:31] offset:4704
    s_waitcnt lgkmcnt(0)
    s_barrier
    ds_read_b128 v[122:125], v120 offset:18432
    ds_read_b128 v[126:129], v120 offset:18448
    ds_read_b128 v[130:133], v120 offset:27648
    ds_read_b128 v[134:137], v120 offset:27664
    s_waitcnt lgkmcnt(0)
    v_pk_add_f32 v[122:123], v[122:123], v[130:131]
    v_pk_add_f32 v[124:125], v[124:125], v[132:133]
    v_pk_add_f32 v[126:127], v[126:127], v[134:135]
    v_pk_add_f32 v[128:129], v[128:129], v[136:137]
    v_cvt_pk_bf16_f32 v138, v122, v123
    v_cvt_pk_bf16_f32 v139, v124, v125
    v_cvt_pk_bf16_f32 v140, v126, v127
    v_cvt_pk_bf16_f32 v141, v128, v129
    v_lshlrev_b32 v122, 16, v138
    v_and_b32 v123, s6, v138
    v_lshlrev_b32 v124, 16, v139
    v_and_b32 v125, s6, v139
    v_lshlrev_b32 v126, 16, v140
    v_and_b32 v127, s6, v140
    v_lshlrev_b32 v128, 16, v141
    v_and_b32 v129, s6, v141
    v_pk_add_f32 v[122:123], v[122:123], v[160:161]
    v_pk_add_f32 v[124:125], v[124:125], v[162:163]
    v_pk_add_f32 v[126:127], v[126:127], v[164:165]
    v_pk_add_f32 v[128:129], v[128:129], v[166:167]
    v_cvt_pk_bf16_f32 v138, v122, v123
    v_cvt_pk_bf16_f32 v139, v124, v125
    v_cvt_pk_bf16_f32 v140, v126, v127
    v_cvt_pk_bf16_f32 v141, v128, v129
    v_lshlrev_b32 v122, 16, v138
    v_and_b32 v123, s6, v138
    v_lshlrev_b32 v124, 16, v139
    v_and_b32 v125, s6, v139
    v_lshlrev_b32 v126, 16, v140
    v_and_b32 v127, s6, v140
    v_lshlrev_b32 v128, 16, v141
    v_and_b32 v129, s6, v141
    v_pk_mul_f32 v[122:123], v[122:123], v[152:153]
    v_pk_mul_f32 v[124:125], v[124:125], v[154:155]
    v_pk_mul_f32 v[126:127], v[126:127], v[156:157]
    v_pk_mul_f32 v[128:129], v[128:129], v[158:159]
    v_cvt_pk_bf16_f32 v138, v122, v123
    v_cvt_pk_bf16_f32 v139, v124, v125
    v_cvt_pk_bf16_f32 v140, v126, v127
    v_cvt_pk_bf16_f32 v141, v128, v129
    v_lshlrev_b32 v122, 16, v138
    v_and_b32 v123, s6, v138
    v_lshlrev_b32 v124, 16, v139
    v_and_b32 v125, s6, v139
    v_lshlrev_b32 v126, 16, v140
    v_and_b32 v127, s6, v140
    v_lshlrev_b32 v128, 16, v141
    v_and_b32 v129, s6, v141
    v_pk_mul_f32 v[122:123], v[122:123], v[12:13]
    v_pk_mul_f32 v[124:125], v[124:125], v[12:13]
    v_pk_mul_f32 v[126:127], v[126:127], v[12:13]
    v_pk_mul_f32 v[128:129], v[128:129], v[12:13]
    v_cvt_pk_bf16_f32 v138, v122, v123
    v_cvt_pk_bf16_f32 v139, v124, v125
    v_cvt_pk_bf16_f32 v140, v126, v127
    v_cvt_pk_bf16_f32 v141, v128, v129
    v_lshlrev_b32 v122, 16, v138
    v_and_b32 v123, s6, v138
    v_lshlrev_b32 v124, 16, v139
    v_and_b32 v125, s6, v139
    v_lshlrev_b32 v126, 16, v140
    v_and_b32 v127, s6, v140
    v_lshlrev_b32 v128, 16, v141
    v_and_b32 v129, s6, v141
    v_pk_add_f32 v[122:123], v[122:123], v[144:145]
    v_pk_add_f32 v[124:125], v[124:125], v[146:147]
    v_pk_add_f32 v[126:127], v[126:127], v[148:149]
    v_pk_add_f32 v[128:129], v[128:129], v[150:151]
    v_cvt_pk_bf16_f32 v138, v122, v123
    v_cvt_pk_bf16_f32 v139, v124, v125
    v_cvt_pk_bf16_f32 v140, v126, v127
    v_cvt_pk_bf16_f32 v141, v128, v129
    buffer_store_dwordx4 v[138:141], v121, s[52:55], s12 offen
    s_endpgm
L_k2_side:
    s_sub_u32 s4, s4, 4
    s_mul_hi_u32 s7, s2, 153391690
    s_mul_i32 s8, s7, 28
    s_sub_u32 s8, s2, s8
    v_subrev_u32 v3, 256, v0
    v_lshlrev_b32 v7, 2, v1
    v_and_b32 v8, 7, v1
    v_lshlrev_b32 v8, 2, v8
    s_cmp_ge_u32 s8, 14
    s_cselect_b32 s13, 14, 0
    s_cselect_b32 s10, 256, 0
    s_sub_u32 s13, s8, s13
    s_lshl_b32 s11, s4, 11
    s_add_u32 s11, s11, 86592
    v_lshrrev_b32 v6, 3, v1
    v_lshl_add_u32 v180, v6, 8, s11
    v_and_b32 v6, 1, v1
    v_lshl_add_u32 v180, v6, 5, v180
    v_bfe_u32 v6, v1, 1, 1
    v_lshl_add_u32 v180, v6, 7, v180
    v_bfe_u32 v6, v1, 2, 1
    v_lshl_add_u32 v180, v6, 6, v180
    v_lshl_add_u32 v181, v1, 4, s11
    s_lshl_b32 s11, s13, 3
    v_lshrrev_b32 v6, 4, v1
    v_add_u32 v6, s11, v6
    s_mov_b32 s11, 28672
    v_mul_lo_u32 v9, v6, s11
    v_and_b32 v6, 15, v1
    v_lshl_add_u32 v9, v6, 4, v9
    s_mul_i32 s14, s7, 7
    s_add_u32 s14, s14, s4
    s_lshl_b32 s11, s14, 9
    s_add_u32 s11, s11, s10
    s_add_u32 s11, s11, 16777216
    s_mul_i32 s56, s14, 28672
    s_lshl_b32 s57, s13, 8
    s_add_u32 s56, s56, s57
    s_lshl_b32 s57, s14, 5
    s_add_u32 s57, s57, 6362368
    s_lshl_b32 s15, s3, 13
    s_add_u32 s15, s15, 2097152
    v_lshlrev_b32 v4, 4, v3
    v_lshlrev_b32 v5, 5, v3
    v_and_b32 v11, 3, v3
    v_lshlrev_b32 v11, 8, v11
    v_bfe_u32 v6, v3, 2, 4
    v_lshl_add_u32 v11, v6, 4, v11
    v_lshrrev_b32 v6, 6, v3
    v_lshl_add_u32 v11, v6, 10, v11
    s_mul_hi_u32 s72, s2, 613566757
    s_mul_i32 s73, s72, 7
    s_sub_u32 s73, s2, s73
    v_lshrrev_b32 v6, 5, v3
    v_and_b32 v10, 31, v3
    v_mul_u32_u24 v13, 7168, v6
    v_lshl_add_u32 v13, v10, 2, v13
    v_lshlrev_b32 v14, 9, v6
    v_and_b32 v14, 512, v14
    v_lshrrev_b32 v6, 1, v6
    v_lshl_add_u32 v14, v6, 11, v14
    v_and_b32 v15, 1, v10
    v_lshl_add_u32 v14, v15, 5, v14
    v_bfe_u32 v15, v10, 1, 1
    v_lshl_add_u32 v14, v15, 7, v14
    v_bfe_u32 v15, v10, 2, 1
    v_lshl_add_u32 v14, v15, 6, v14
    v_bfe_u32 v15, v10, 3, 1
    v_lshl_add_u32 v14, v15, 8, v14
    v_lshrrev_b32 v15, 4, v10
    v_lshl_add_u32 v14, v15, 10, v14
    v_add_u32 v14, 86592, v14
    s_mul_i32 s74, s72, 57344
    s_lshl_b32 s75, s73, 7
    s_add_u32 s74, s74, s75
    s_mul_i32 s75, s73, 229376
    s_lshl_b32 s72, s72, 13
    s_add_u32 s75, s75, s72
    s_add_u32 s75, s75, 20971520
    s_lshl_b32 s72, s4, 11
    s_add_u32 s75, s75, s72
    s_cmp_ge_u32 s2, 196
    s_cselect_b32 s75, 4294963200, s75
    v_lshlrev_b32 v182, 4, v1
    s_waitcnt lgkmcnt(0)
    s_cmp_ge_u32 s8, 14
    s_cselect_b32 s46, s32, s30
    s_cselect_b32 s47, s33, s31
    s_mov_b32 s48, s46
    s_mov_b32 s49, s47
    s_mov_b32 s50, 1605632
    s_mov_b32 s51, 131072
    s_mov_b32 s52, s44
    s_mov_b32 s53, s45
    s_mov_b32 s54, 22577152
    s_mov_b32 s55, 131072
    s_add_u32 s98, s44, s9
    s_addc_u32 s99, s45, 0
    s_load_dword s60, s[98:99], 0
    s_load_dword s63, s[98:99], 10752
    s_load_dword s61, s[98:99], 1792
    s_load_dword s64, s[98:99], 12544
    s_load_dword s62, s[98:99], 3584
    s_load_dword s65, s[98:99], 14336
    s_lshl_b32 s9, s3, 2
    s_add_u32 s58, s26, s9
    s_addc_u32 s59, s27, 0
    s_load_dword s66, s[58:59], 0
    s_mov_b32 s71, 6291456
    buffer_load_dwordx4 v[40:43], v4, s[52:55], s15 offen
    buffer_load_dwordx4 v[48:51], v5, s[52:55], s71 offen offset:0
    buffer_load_dwordx4 v[52:55], v5, s[52:55], s71 offen offset:16
    s_add_u32 s70, s57, 0
    buffer_load_dword v32, v8, s[52:55], s70 offen
    s_add_u32 s70, s57, 1792
    buffer_load_dword v33, v8, s[52:55], s70 offen
    s_add_u32 s70, s57, 10752
    buffer_load_dword v34, v8, s[52:55], s70 offen
    s_add_u32 s70, s57, 12544
    buffer_load_dword v35, v8, s[52:55], s70 offen
    s_add_u32 s70, s57, 128
    buffer_load_dword v36, v8, s[52:55], s70 offen
    s_add_u32 s70, s57, 1920
    buffer_load_dword v37, v8, s[52:55], s70 offen
    s_add_u32 s70, s57, 10880
    buffer_load_dword v38, v8, s[52:55], s70 offen
    s_add_u32 s70, s57, 12672
    buffer_load_dword v39, v8, s[52:55], s70 offen
    s_add_u32 s70, s56, 0
    buffer_load_dword v16, v7, s[48:51], s70 offen nt
    s_add_u32 s70, s56, 3584
    buffer_load_dword v17, v7, s[48:51], s70 offen nt
    s_add_u32 s70, s56, 7168
    buffer_load_dword v18, v7, s[48:51], s70 offen nt
    s_add_u32 s70, s56, 10752
    buffer_load_dword v19, v7, s[48:51], s70 offen nt
    s_add_u32 s70, s56, 14336
    buffer_load_dword v20, v7, s[48:51], s70 offen nt
    s_add_u32 s70, s56, 17920
    buffer_load_dword v21, v7, s[48:51], s70 offen nt
    s_add_u32 s70, s56, 21504
    buffer_load_dword v22, v7, s[48:51], s70 offen nt
    s_add_u32 s70, s56, 25088
    buffer_load_dword v23, v7, s[48:51], s70 offen nt
    s_mov_b32 s92, s34
    s_mov_b32 s93, s35
    s_mov_b32 s94, 1605632
    s_mov_b32 s95, 131072
    s_add_u32 s70, s56, 114688
    buffer_load_dword v24, v7, s[48:51], s70 offen nt
    s_add_u32 s70, s56, 118272
    buffer_load_dword v25, v7, s[48:51], s70 offen nt
    s_add_u32 s70, s56, 121856
    buffer_load_dword v26, v7, s[48:51], s70 offen nt
    s_add_u32 s70, s56, 125440
    buffer_load_dword v27, v7, s[48:51], s70 offen nt
    s_add_u32 s70, s56, 129024
    buffer_load_dword v28, v7, s[48:51], s70 offen nt
    s_add_u32 s70, s56, 132608
    buffer_load_dword v29, v7, s[48:51], s70 offen nt
    s_add_u32 s70, s56, 136192
    buffer_load_dword v30, v7, s[48:51], s70 offen nt
    s_add_u32 s70, s56, 139776
    buffer_load_dword v31, v7, s[48:51], s70 offen nt
    s_add_u32 s70, s74, 0
    buffer_load_dword v128, v13, s[92:95], s70 offen nt
    s_add_u32 s70, s74, 896
    buffer_load_dword v129, v13, s[92:95], s70 offen nt
    s_add_u32 s70, s74, 1792
    buffer_load_dword v130, v13, s[92:95], s70 offen nt
    s_add_u32 s70, s74, 2688
    buffer_load_dword v131, v13, s[92:95], s70 offen nt
    s_add_u32 s70, s74, 3584
    buffer_load_dword v132, v13, s[92:95], s70 offen nt
    s_add_u32 s70, s74, 4480
    buffer_load_dword v133, v13, s[92:95], s70 offen nt
    s_add_u32 s70, s74, 5376
    buffer_load_dword v134, v13, s[92:95], s70 offen nt
    s_add_u32 s70, s74, 6272
    buffer_load_dword v135, v13, s[92:95], s70 offen nt
    v_mov_b32 v96, 0
    v_mov_b32 v124, 0
    v_mov_b32 v97, 0
    v_mov_b32 v125, 0
    v_mov_b32 v98, 0
    v_mov_b32 v126, 0
    v_mov_b32 v99, 0
    v_mov_b32 v127, 0
    v_lshrrev_b32 v144, 2, v3
    v_lshlrev_b32 v144, 4, v144
    v_lshl_add_u32 v144, v3, 5, v144
    v_add_u32 v144, 45568, v144
    v_lshlrev_b32 v145, 4, v3
    s_mul_i32 s12, s3, 8704
    s_add_u32 s12, s12, 4194304
    s_mov_b32 s97, s12
    s_mov_b32 s72, 84148480
    s_mov_b32 s73, 117834498
    s_waitcnt vmcnt(0)
    v_perm_b32 v136, v129, v128, s72
    v_perm_b32 v140, v129, v128, s73
    v_perm_b32 v137, v131, v130, s72
    v_perm_b32 v141, v131, v130, s73
    v_perm_b32 v138, v133, v132, s72
    v_perm_b32 v142, v133, v132, s73
    v_perm_b32 v139, v135, v134, s72
    v_perm_b32 v143, v135, v134, s73
    s_waitcnt lgkmcnt(0)
    ds_write_b128 v14, v[136:139]
    ds_write_b128 v14, v[140:143] offset:16
    ds_read_b128 v[136:139], v181
    ds_read_b128 v[140:143], v181 offset:1024
    s_waitcnt lgkmcnt(0)
    buffer_store_dwordx4 v[136:139], v182, s[52:55], s75 offen sc1
    buffer_store_dwordx4 v[140:143], v182, s[52:55], s75 offen offset:1024 sc1
    v_add_f32 v32, v32, v34
    v_add_f32 v33, v33, v35
    v_cvt_pk_bf16_f32 v34, v32, v33
    v_lshlrev_b32 v32, 16, v34
    v_and_b32 v33, s6, v34
    v_add_f32 v33, 1.0, v33
    v_cvt_pk_bf16_f32 v33, v33, v33
    v_lshlrev_b32 v33, 16, v33
    v_add_f32 v36, v36, v38
    v_add_f32 v37, v37, v39
    v_cvt_pk_bf16_f32 v38, v36, v37
    v_lshlrev_b32 v36, 16, v38
    v_and_b32 v37, s6, v38
    v_add_f32 v37, 1.0, v37
    v_cvt_pk_bf16_f32 v37, v37, v37
    v_lshlrev_b32 v37, 16, v37
    v_readlane_b32 s16, v32, 0
    v_readlane_b32 s24, v33, 0
    v_readlane_b32 s17, v32, 1
    v_readlane_b32 s25, v33, 1
    v_readlane_b32 s18, v32, 2
    v_readlane_b32 s26, v33, 2
    v_readlane_b32 s19, v32, 3
    v_readlane_b32 s27, v33, 3
    v_readlane_b32 s20, v32, 4
    v_readlane_b32 s28, v33, 4
    v_readlane_b32 s21, v32, 5
    v_readlane_b32 s29, v33, 5
    v_readlane_b32 s22, v32, 6
    v_readlane_b32 s30, v33, 6
    v_readlane_b32 s23, v32, 7
    v_readlane_b32 s31, v33, 7
    v_lshlrev_b32 v100, 16, v16
    v_and_b32 v108, s6, v16
    v_lshlrev_b32 v101, 16, v17
    v_and_b32 v109, s6, v17
    v_lshlrev_b32 v102, 16, v18
    v_and_b32 v110, s6, v18
    v_lshlrev_b32 v103, 16, v19
    v_and_b32 v111, s6, v19
    v_lshlrev_b32 v104, 16, v20
    v_and_b32 v112, s6, v20
    v_lshlrev_b32 v105, 16, v21
    v_and_b32 v113, s6, v21
    v_lshlrev_b32 v106, 16, v22
    v_and_b32 v114, s6, v22
    v_lshlrev_b32 v107, 16, v23
    v_and_b32 v115, s6, v23
    v_fmac_f32 v126, s16, v100
    v_fmac_f32 v127, s16, v108
    v_mul_f32 v100, s24, v100
    v_mul_f32 v108, s24, v108
    v_fmac_f32 v98, s17, v101
    v_fmac_f32 v99, s17, v109
    v_mul_f32 v101, s25, v101
    v_mul_f32 v109, s25, v109
    v_fmac_f32 v126, s18, v102
    v_fmac_f32 v127, s18, v110
    v_mul_f32 v102, s26, v102
    v_mul_f32 v110, s26, v110
    v_fmac_f32 v98, s19, v103
    v_fmac_f32 v99, s19, v111
    v_mul_f32 v103, s27, v103
    v_mul_f32 v111, s27, v111
    v_fmac_f32 v126, s20, v104
    v_fmac_f32 v127, s20, v112
    v_mul_f32 v104, s28, v104
    v_mul_f32 v112, s28, v112
    v_fmac_f32 v98, s21, v105
    v_fmac_f32 v99, s21, v113
    v_mul_f32 v105, s29, v105
    v_mul_f32 v113, s29, v113
    v_fmac_f32 v126, s22, v106
    v_fmac_f32 v127, s22, v114
    v_mul_f32 v106, s30, v106
    v_mul_f32 v114, s30, v114
    v_fmac_f32 v98, s23, v107
    v_fmac_f32 v99, s23, v115
    v_mul_f32 v107, s31, v107
    v_mul_f32 v115, s31, v115
    v_cvt_pk_bf16_f32 v116, v100, v101
    v_cvt_pk_bf16_f32 v120, v108, v109
    v_cvt_pk_bf16_f32 v117, v102, v103
    v_cvt_pk_bf16_f32 v121, v110, v111
    v_cvt_pk_bf16_f32 v118, v104, v105
    v_cvt_pk_bf16_f32 v122, v112, v113
    v_cvt_pk_bf16_f32 v119, v106, v107
    v_cvt_pk_bf16_f32 v123, v114, v115
    s_add_u32 s70, s11, 0
    s_add_u32 s71, s70, 114688
    ds_write_b128 v180, v[116:119]
    ds_write_b128 v180, v[120:123] offset:16
    ds_read_b128 v[184:187], v181
    ds_read_b128 v[188:191], v181 offset:1024
    v_lshlrev_b32 v100, 16, v116
    v_and_b32 v101, s6, v116
    v_lshlrev_b32 v108, 16, v120
    v_and_b32 v109, s6, v120
    v_lshlrev_b32 v102, 16, v117
    v_and_b32 v103, s6, v117
    v_lshlrev_b32 v110, 16, v121
    v_and_b32 v111, s6, v121
    v_lshlrev_b32 v104, 16, v118
    v_and_b32 v105, s6, v118
    v_lshlrev_b32 v112, 16, v122
    v_and_b32 v113, s6, v122
    v_lshlrev_b32 v106, 16, v119
    v_and_b32 v107, s6, v119
    v_lshlrev_b32 v114, 16, v123
    v_and_b32 v115, s6, v123
    v_add_f32 v100, v100, v104
    v_add_f32 v108, v108, v112
    v_add_f32 v101, v101, v105
    v_add_f32 v109, v109, v113
    v_add_f32 v102, v102, v106
    v_add_f32 v110, v110, v114
    v_add_f32 v103, v103, v107
    v_add_f32 v111, v111, v115
    v_add_f32 v100, v100, v102
    v_add_f32 v108, v108, v110
    v_add_f32 v101, v101, v103
    v_add_f32 v109, v109, v111
    v_add_f32 v96, v96, v100
    v_add_f32 v97, v97, v108
    v_add_f32 v124, v124, v101
    v_add_f32 v125, v125, v109
    s_waitcnt lgkmcnt(0)
    buffer_store_dwordx4 v[184:187], v9, s[52:55], s70 offen sc1
    buffer_store_dwordx4 v[188:191], v9, s[52:55], s71 offen sc1
    s_nop 1
    v_mov_b32 v191, v191
    s_cmp_eq_u32 s4, 3
    s_cbranch_scc1 L_k2_skip1
    v_readlane_b32 s16, v36, 0
    v_readlane_b32 s24, v37, 0
    v_readlane_b32 s17, v36, 1
    v_readlane_b32 s25, v37, 1
    v_readlane_b32 s18, v36, 2
    v_readlane_b32 s26, v37, 2
    v_readlane_b32 s19, v36, 3
    v_readlane_b32 s27, v37, 3
    v_readlane_b32 s20, v36, 4
    v_readlane_b32 s28, v37, 4
    v_readlane_b32 s21, v36, 5
    v_readlane_b32 s29, v37, 5
    v_readlane_b32 s22, v36, 6
    v_readlane_b32 s30, v37, 6
    v_readlane_b32 s23, v36, 7
    v_readlane_b32 s31, v37, 7
    v_lshlrev_b32 v100, 16, v24
    v_and_b32 v108, s6, v24
    v_lshlrev_b32 v101, 16, v25
    v_and_b32 v109, s6, v25
    v_lshlrev_b32 v102, 16, v26
    v_and_b32 v110, s6, v26
    v_lshlrev_b32 v103, 16, v27
    v_and_b32 v111, s6, v27
    v_lshlrev_b32 v104, 16, v28
    v_and_b32 v112, s6, v28
    v_lshlrev_b32 v105, 16, v29
    v_and_b32 v113, s6, v29
    v_lshlrev_b32 v106, 16, v30
    v_and_b32 v114, s6, v30
    v_lshlrev_b32 v107, 16, v31
    v_and_b32 v115, s6, v31
    v_fmac_f32 v126, s16, v100
    v_fmac_f32 v127, s16, v108
    v_mul_f32 v100, s24, v100
    v_mul_f32 v108, s24, v108
    v_fmac_f32 v98, s17, v101
    v_fmac_f32 v99, s17, v109
    v_mul_f32 v101, s25, v101
    v_mul_f32 v109, s25, v109
    v_fmac_f32 v126, s18, v102
    v_fmac_f32 v127, s18, v110
    v_mul_f32 v102, s26, v102
    v_mul_f32 v110, s26, v110
    v_fmac_f32 v98, s19, v103
    v_fmac_f32 v99, s19, v111
    v_mul_f32 v103, s27, v103
    v_mul_f32 v111, s27, v111
    v_fmac_f32 v126, s20, v104
    v_fmac_f32 v127, s20, v112
    v_mul_f32 v104, s28, v104
    v_mul_f32 v112, s28, v112
    v_fmac_f32 v98, s21, v105
    v_fmac_f32 v99, s21, v113
    v_mul_f32 v105, s29, v105
    v_mul_f32 v113, s29, v113
    v_fmac_f32 v126, s22, v106
    v_fmac_f32 v127, s22, v114
    v_mul_f32 v106, s30, v106
    v_mul_f32 v114, s30, v114
    v_fmac_f32 v98, s23, v107
    v_fmac_f32 v99, s23, v115
    v_mul_f32 v107, s31, v107
    v_mul_f32 v115, s31, v115
    v_cvt_pk_bf16_f32 v116, v100, v101
    v_cvt_pk_bf16_f32 v120, v108, v109
    v_cvt_pk_bf16_f32 v117, v102, v103
    v_cvt_pk_bf16_f32 v121, v110, v111
    v_cvt_pk_bf16_f32 v118, v104, v105
    v_cvt_pk_bf16_f32 v122, v112, v113
    v_cvt_pk_bf16_f32 v119, v106, v107
    v_cvt_pk_bf16_f32 v123, v114, v115
    s_add_u32 s70, s11, 2048
    s_add_u32 s71, s70, 114688
    ds_write_b128 v180, v[116:119]
    ds_write_b128 v180, v[120:123] offset:16
    ds_read_b128 v[184:187], v181
    ds_read_b128 v[188:191], v181 offset:1024
    v_lshlrev_b32 v100, 16, v116
    v_and_b32 v101, s6, v116
    v_lshlrev_b32 v108, 16, v120
    v_and_b32 v109, s6, v120
    v_lshlrev_b32 v102, 16, v117
    v_and_b32 v103, s6, v117
    v_lshlrev_b32 v110, 16, v121
    v_and_b32 v111, s6, v121
    v_lshlrev_b32 v104, 16, v118
    v_and_b32 v105, s6, v118
    v_lshlrev_b32 v112, 16, v122
    v_and_b32 v113, s6, v122
    v_lshlrev_b32 v106, 16, v119
    v_and_b32 v107, s6, v119
    v_lshlrev_b32 v114, 16, v123
    v_and_b32 v115, s6, v123
    v_add_f32 v100, v100, v104
    v_add_f32 v108, v108, v112
    v_add_f32 v101, v101, v105
    v_add_f32 v109, v109, v113
    v_add_f32 v102, v102, v106
    v_add_f32 v110, v110, v114
    v_add_f32 v103, v103, v107
    v_add_f32 v111, v111, v115
    v_add_f32 v100, v100, v102
    v_add_f32 v108, v108, v110
    v_add_f32 v101, v101, v103
    v_add_f32 v109, v109, v111
    v_add_f32 v96, v96, v100
    v_add_f32 v97, v97, v108
    v_add_f32 v124, v124, v101
    v_add_f32 v125, v125, v109
    s_waitcnt lgkmcnt(0)
    buffer_store_dwordx4 v[184:187], v9, s[52:55], s70 offen sc1
    buffer_store_dwordx4 v[188:191], v9, s[52:55], s71 offen sc1
    s_nop 1
    v_mov_b32 v191, v191
L_k2_skip1:
    s_nop 4
    v_add_f32 v96, v96, v124
    v_add_f32 v97, v97, v125
    v_add_f32 v98, v98, v126
    v_add_f32 v99, v99, v127
    s_lshl_b32 s70, s4, 10
    s_add_u32 s70, s70, 82432
    v_lshl_add_u32 v6, v1, 4, s70
    ds_write_b128 v6, v[96:99]
    s_waitcnt lgkmcnt(0)
    v_mov_b32 v12, 86528
    v_mov_b32 v166, s61
    v_mov_b32 v167, s60
    v_mov_b32 v170, s62
    v_add_f32 v166, s64, v166
    v_add_f32 v167, s63, v167
    v_add_f32 v170, s65, v170
    v_cvt_pk_bf16_f32 v169, v166, v167
    v_lshlrev_b32 v166, 16, v169
    v_and_b32 v167, s6, v169
    v_cvt_pk_bf16_f32 v170, v170, v170
    v_lshlrev_b32 v170, 16, v170
    v_mov_b32 v171, v170
    v_add_f32 v166, 1.0, v166
    v_cvt_pk_bf16_f32 v166, v166, v166
    v_lshlrev_b32 v166, 16, v166
    v_mov_b32 v168, s66
    v_lshlrev_b32 v168, 16, v168
    v_lshlrev_b32 v72, 16, v40
    v_and_b32 v73, s6, v40
    v_lshlrev_b32 v74, 16, v41
    v_and_b32 v75, s6, v41
    v_lshlrev_b32 v76, 16, v42
    v_and_b32 v77, s6, v42
    v_lshlrev_b32 v78, 16, v43
    v_and_b32 v79, s6, v43
    v_and_b32 v64, s6, v48
    v_lshlrev_b32 v56, 16, v48
    v_and_b32 v65, s6, v49
    v_lshlrev_b32 v57, 16, v49
    v_and_b32 v66, s6, v50
    v_lshlrev_b32 v58, 16, v50
    v_and_b32 v67, s6, v51
    v_lshlrev_b32 v59, 16, v51
    v_and_b32 v68, s6, v52
    v_lshlrev_b32 v60, 16, v52
    v_and_b32 v69, s6, v53
    v_lshlrev_b32 v61, 16, v53
    v_and_b32 v70, s6, v54
    v_lshlrev_b32 v62, 16, v54
    v_and_b32 v71, s6, v55
    v_lshlrev_b32 v63, 16, v55
    v_rcp_f32 v64, v64
    v_sub_f32 v88, v72, v56
    v_rcp_f32 v65, v65
    v_sub_f32 v89, v73, v57
    v_rcp_f32 v66, v66
    v_sub_f32 v90, v74, v58
    v_rcp_f32 v67, v67
    v_sub_f32 v91, v75, v59
    v_rcp_f32 v68, v68
    v_sub_f32 v92, v76, v60
    v_rcp_f32 v69, v69
    v_sub_f32 v93, v77, v61
    v_rcp_f32 v70, v70
    v_sub_f32 v94, v78, v62
    v_rcp_f32 v71, v71
    v_sub_f32 v95, v79, v63
    v_cvt_pk_bf16_f32 v80, v88, v89
    v_cvt_pk_bf16_f32 v81, v90, v91
    v_cvt_pk_bf16_f32 v82, v92, v93
    v_cvt_pk_bf16_f32 v83, v94, v95
    v_lshlrev_b32 v88, 16, v80
    v_and_b32 v89, s6, v80
    v_lshlrev_b32 v90, 16, v81
    v_and_b32 v91, s6, v81
    v_lshlrev_b32 v92, 16, v82
    v_and_b32 v93, s6, v82
    v_lshlrev_b32 v94, 16, v83
    v_and_b32 v95, s6, v83
    v_mul_f32 v88, v88, v64
    v_mul_f32 v89, v89, v65
    v_mul_f32 v90, v90, v66
    v_mul_f32 v91, v91, v67
    v_mul_f32 v92, v92, v68
    v_mul_f32 v93, v93, v69
    v_mul_f32 v94, v94, v70
    v_mul_f32 v95, v95, v71
    v_cvt_pk_bf16_f32 v80, v88, v89
    v_cvt_pk_bf16_f32 v81, v90, v91
    v_cvt_pk_bf16_f32 v82, v92, v93
    v_cvt_pk_bf16_f32 v83, v94, v95
    v_lshlrev_b32 v88, 16, v80
    v_and_b32 v89, s6, v80
    v_lshlrev_b32 v90, 16, v81
    v_and_b32 v91, s6, v81
    v_lshlrev_b32 v92, 16, v82
    v_and_b32 v93, s6, v82
    v_lshlrev_b32 v94, 16, v83
    v_and_b32 v95, s6, v83
    v_mul_f32 v88, v88, v166
    v_mul_f32 v89, v89, v166
    v_mul_f32 v90, v90, v166
    v_mul_f32 v91, v91, v166
    v_mul_f32 v92, v92, v166
    v_mul_f32 v93, v93, v166
    v_mul_f32 v94, v94, v166
    v_mul_f32 v95, v95, v166
    v_cvt_pk_bf16_f32 v80, v88, v89
    v_cvt_pk_bf16_f32 v81, v90, v91
    v_cvt_pk_bf16_f32 v82, v92, v93
    v_cvt_pk_bf16_f32 v83, v94, v95
    v_lshlrev_b32 v88, 16, v80
    v_and_b32 v89, s6, v80
    v_lshlrev_b32 v90, 16, v81
    v_and_b32 v91, s6, v81
    v_lshlrev_b32 v92, 16, v82
    v_and_b32 v93, s6, v82
    v_lshlrev_b32 v94, 16, v83
    v_and_b32 v95, s6, v83
    v_add_f32 v88, v88, v167
    v_add_f32 v89, v89, v167
    v_add_f32 v90, v90, v167
    v_add_f32 v91, v91, v167
    v_add_f32 v92, v92, v167
    v_add_f32 v93, v93, v167
    v_add_f32 v94, v94, v167
    v_add_f32 v95, v95, v167
    v_cvt_pk_bf16_f32 v80, v88, v89
    v_cvt_pk_bf16_f32 v81, v90, v91
    v_cvt_pk_bf16_f32 v82, v92, v93
    v_cvt_pk_bf16_f32 v83, v94, v95
    v_lshlrev_b32 v88, 16, v80
    v_and_b32 v89, s6, v80
    v_lshlrev_b32 v90, 16, v81
    v_and_b32 v91, s6, v81
    v_lshlrev_b32 v92, 16, v82
    v_and_b32 v93, s6, v82
    v_lshlrev_b32 v94, 16, v83
    v_and_b32 v95, s6, v83
L_k2_fws:
    ds_read_b128 v[44:47], v12
    s_waitcnt lgkmcnt(0)
    v_and_b32 v44, v44, v45
    v_and_b32 v46, v46, v47
    v_and_b32 v44, v44, v46
    s_nop 0
    v_readfirstlane_b32 s70, v44
    s_nop 1
    s_cmp_eq_u32 s70, 0
    s_cbranch_scc1 L_k2_fws
    ds_read_b128 v[44:47], v11 offset:35328
    s_waitcnt lgkmcnt(0)
    v_lshlrev_b32 v179, 16, v44
    v_and_b32 v178, s6, v44
    v_lshlrev_b32 v177, 16, v45
    v_and_b32 v176, s6, v45
    v_lshlrev_b32 v175, 16, v46
    v_and_b32 v174, s6, v46
    v_lshlrev_b32 v173, 16, v47
    v_and_b32 v172, s6, v47
    v_mul_f32 v172, v172, v168
    v_mul_f32 v173, v173, v168
    v_mul_f32 v174, v174, v168
    v_mul_f32 v175, v175, v168
    v_mul_f32 v176, v176, v168
    v_mul_f32 v177, v177, v168
    v_mul_f32 v178, v178, v168
    v_mul_f32 v179, v179, v168
    v_cvt_pk_bf16_f32 v80, v172, v173
    v_cvt_pk_bf16_f32 v81, v174, v175
    v_cvt_pk_bf16_f32 v82, v176, v177
    v_cvt_pk_bf16_f32 v83, v178, v179
    v_lshlrev_b32 v172, 16, v80
    v_and_b32 v173, s6, v80
    v_lshlrev_b32 v174, 16, v81
    v_and_b32 v175, s6, v81
    v_lshlrev_b32 v176, 16, v82
    v_and_b32 v177, s6, v82
    v_lshlrev_b32 v178, 16, v83
    v_and_b32 v179, s6, v83
    s_waitcnt lgkmcnt(0)
    s_barrier
    s_mov_b32 s12, s97
    ds_read_b128 v[146:149], v144 offset:0
    ds_read_b128 v[150:153], v144 offset:16
    ds_read_b128 v[154:157], v144 offset:9216
    ds_read_b128 v[158:161], v144 offset:9232
    s_waitcnt lgkmcnt(0)
    v_pk_add_f32 v[146:147], v[146:147], v[154:155]
    v_pk_add_f32 v[148:149], v[148:149], v[156:157]
    v_pk_add_f32 v[150:151], v[150:151], v[158:159]
    v_pk_add_f32 v[152:153], v[152:153], v[160:161]
    v_cvt_pk_bf16_f32 v162, v146, v147
    v_cvt_pk_bf16_f32 v163, v148, v149
    v_cvt_pk_bf16_f32 v164, v150, v151
    v_cvt_pk_bf16_f32 v165, v152, v153
    v_lshlrev_b32 v146, 16, v162
    v_and_b32 v147, s6, v162
    v_lshlrev_b32 v148, 16, v163
    v_and_b32 v149, s6, v163
    v_lshlrev_b32 v150, 16, v164
    v_and_b32 v151, s6, v164
    v_lshlrev_b32 v152, 16, v165
    v_and_b32 v153, s6, v165
    v_pk_add_f32 v[146:147], v[146:147], v[172:173]
    v_pk_add_f32 v[148:149], v[148:149], v[174:175]
    v_pk_add_f32 v[150:151], v[150:151], v[176:177]
    v_pk_add_f32 v[152:153], v[152:153], v[178:179]
    v_cvt_pk_bf16_f32 v162, v146, v147
    v_cvt_pk_bf16_f32 v163, v148, v149
    v_cvt_pk_bf16_f32 v164, v150, v151
    v_cvt_pk_bf16_f32 v165, v152, v153
    v_lshlrev_b32 v146, 16, v162
    v_and_b32 v147, s6, v162
    v_lshlrev_b32 v148, 16, v163
    v_and_b32 v149, s6, v163
    v_lshlrev_b32 v150, 16, v164
    v_and_b32 v151, s6, v164
    v_lshlrev_b32 v152, 16, v165
    v_and_b32 v153, s6, v165
    v_pk_mul_f32 v[146:147], v[146:147], v[88:89]
    v_pk_mul_f32 v[148:149], v[148:149], v[90:91]
    v_pk_mul_f32 v[150:151], v[150:151], v[92:93]
    v_pk_mul_f32 v[152:153], v[152:153], v[94:95]
    v_cvt_pk_bf16_f32 v162, v146, v147
    v_cvt_pk_bf16_f32 v163, v148, v149
    v_cvt_pk_bf16_f32 v164, v150, v151
    v_cvt_pk_bf16_f32 v165, v152, v153
    v_lshlrev_b32 v146, 16, v162
    v_and_b32 v147, s6, v162
    v_lshlrev_b32 v148, 16, v163
    v_and_b32 v149, s6, v163
    v_lshlrev_b32 v150, 16, v164
    v_and_b32 v151, s6, v164
    v_lshlrev_b32 v152, 16, v165
    v_and_b32 v153, s6, v165
    v_pk_mul_f32 v[146:147], v[146:147], v[170:171]
    v_pk_mul_f32 v[148:149], v[148:149], v[170:171]
    v_pk_mul_f32 v[150:151], v[150:151], v[170:171]
    v_pk_mul_f32 v[152:153], v[152:153], v[170:171]
    v_cvt_pk_bf16_f32 v162, v146, v147
    v_cvt_pk_bf16_f32 v163, v148, v149
    v_cvt_pk_bf16_f32 v164, v150, v151
    v_cvt_pk_bf16_f32 v165, v152, v153
    v_lshlrev_b32 v146, 16, v162
    v_and_b32 v147, s6, v162
    v_lshlrev_b32 v148, 16, v163
    v_and_b32 v149, s6, v163
    v_lshlrev_b32 v150, 16, v164
    v_and_b32 v151, s6, v164
    v_lshlrev_b32 v152, 16, v165
    v_and_b32 v153, s6, v165
    v_pk_add_f32 v[146:147], v[146:147], v[72:73]
    v_pk_add_f32 v[148:149], v[148:149], v[74:75]
    v_pk_add_f32 v[150:151], v[150:151], v[76:77]
    v_pk_add_f32 v[152:153], v[152:153], v[78:79]
    v_cvt_pk_bf16_f32 v162, v146, v147
    v_cvt_pk_bf16_f32 v163, v148, v149
    v_cvt_pk_bf16_f32 v164, v150, v151
    v_cvt_pk_bf16_f32 v165, v152, v153
    buffer_store_dwordx4 v[162:165], v145, s[52:55], s12 offen
    s_cmp_lg_u32 s4, 0
    s_cbranch_scc1 L_k2_exit
    v_lshlrev_b32 v6, 4, v1
    v_add_u32 v6, 82432, v6
    ds_read_b128 v[16:19], v6 offset:0
    ds_read_b128 v[20:23], v6 offset:1024
    ds_read_b128 v[24:27], v6 offset:2048
    ds_read_b128 v[28:31], v6 offset:3072
    s_waitcnt lgkmcnt(0)
    v_add_f32 v16, v16, v20
    v_add_f32 v24, v24, v28
    v_add_f32 v16, v16, v24
    v_add_f32 v17, v17, v21
    v_add_f32 v25, v25, v29
    v_add_f32 v17, v17, v25
    v_add_f32 v18, v18, v22
    v_add_f32 v26, v26, v30
    v_add_f32 v18, v18, v26
    v_add_f32 v19, v19, v23
    v_add_f32 v27, v27, v31
    v_add_f32 v19, v19, v27
    s_mul_i32 s58, s7, 14336
    s_lshl_b32 s59, s8, 9
    s_add_u32 s58, s58, s59
    s_add_u32 s59, s58, 6553600
    s_add_u32 s58, s58, 6422528
    v_lshlrev_b32 v6, 3, v1
    buffer_store_dwordx2 v[16:17], v6, s[52:55], s58 offen
    buffer_store_dwordx2 v[18:19], v6, s[52:55], s59 offen
    s_cmp_lg_u32 s2, 0
    s_cbranch_scc1 L_k2_exit
    v_lshlrev_b32 v6, 7, v1
    v_mov_b32 v16, 0
    s_mov_b32 s58, 6815744
    buffer_store_dword v16, v6, s[52:55], s58 offen
L_k2_exit:
    s_endpgm
.section .rodata,"a"
.p2align 6
.amdhsa_kernel k2_kernel
  .amdhsa_next_free_vgpr 224
  .amdhsa_next_free_sgpr 100
  .amdhsa_accum_offset 192
  .amdhsa_group_segment_fixed_size 0
  .amdhsa_kernarg_size 120
  .amdhsa_user_sgpr_count 2
  .amdhsa_user_sgpr_kernarg_segment_ptr 1
  .amdhsa_system_sgpr_workgroup_id_x 1
.end_amdhsa_kernel
.text
.globl k4_kernel
.p2align 8
.type k4_kernel,@function
k4_kernel:
    s_load_dwordx16 s[16:31], s[0:1], 0
    s_load_dwordx8 s[32:39], s[0:1], 64
    s_load_dwordx4 s[40:43], s[0:1], 96
    s_load_dwordx2 s[44:45], s[0:1], 112
    s_cmp_ge_u32 s2, 256
    s_cbranch_scc1 L_k4_exit
    s_mov_b32 s6, 4294901760
    s_bfe_u32 s3, s2, 65538
    s_lshl_b32 s3, s3, 3
    s_lshr_b32 s4, s2, 5
    s_add_u32 s3, s3, s4
    s_and_b32 s5, s2, 3
    s_lshl_b32 s5, s5, 2
    s_bfe_u32 s4, s2, 131075
    s_add_u32 s5, s5, s4
    v_and_b32 v1, 63, v0
    v_lshrrev_b32 v2, 6, v0
    s_nop 0
    v_readfirstlane_b32 s4, v2
    s_nop 1
    s_cmp_ge_u32 s4, 4
    s_cbranch_scc1 L_k4_load
    v_bfe_u32 v4, v1, 2, 2
    v_and_b32 v5, 3, v1
    v_lshrrev_b32 v7, 5, v1
    v_lshlrev_b32 v8, 4, v1
    v_add_u32 v9, 98304, v8
    v_add_u32 v3, 65536, v8
    v_lshl_add_u32 v6, v7, 3, v4
    v_lshlrev_b32 v10, 8, v6
    v_xor_b32 v6, s4, v4
    v_lshl_add_u32 v10, v6, 6, v10
    v_bfe_u32 v6, v1, 4, 1
    v_lshl_add_u32 v10, v6, 5, v10
    v_lshl_add_u32 v10, v5, 3, v10
    v_add_u32 v11, 65536, v10
    v_add_u32 v12, 155648, v8
    v_cmp_gt_u32 s[88:89], 32, v1
    v_and_b32 v13, 31, v1
    v_lshlrev_b32 v13, 4, v13
    v_mul_u32_u24 v6, 33792, v7
    v_add_u32 v13, v13, v6
    s_mul_i32 s7, s5, 473088
    s_lshl_b32 s13, s3, 11
    s_add_u32 s7, s7, s13
    s_lshl_b32 s13, s4, 9
    s_add_u32 s7, s7, s13
    s_add_u32 s7, s7, 8388608
    s_mov_b32 s8, 991054117
    s_mov_b32 s9, 925353388
    s_mov_b32 s10, 3216550459
    v_mov_b32 v14, 1065369472
    v_mov_b32 v15, 1065369472
    v_mov_b32 v16, 1065369472
    v_mov_b32 v17, 1065369472
    v_and_b32 v18, 31, v1
    v_lshrrev_b32 v19, 3, v18
    v_lshlrev_b32 v19, 2, v19
    v_and_b32 v6, 3, v18
    v_add_u32 v19, v19, v6
    v_bfe_u32 v6, v18, 2, 1
    v_xor_b32 v6, v6, v7
    v_lshl_add_u32 v19, v6, 4, v19
    v_cmp_eq_u32 s[56:57], 0, v19
    v_cmp_eq_u32 s[58:59], 1, v19
    v_cmp_eq_u32 s[60:61], 2, v19
    v_cmp_eq_u32 s[62:63], 3, v19
    v_cmp_eq_u32 s[64:65], 4, v19
    v_cmp_eq_u32 s[66:67], 5, v19
    v_cmp_eq_u32 s[68:69], 6, v19
    v_cmp_eq_u32 s[70:71], 7, v19
    v_cmp_eq_u32 s[72:73], 8, v19
    v_cmp_eq_u32 s[74:75], 9, v19
    v_cmp_eq_u32 s[76:77], 10, v19
    v_cmp_eq_u32 s[78:79], 11, v19
    v_cmp_eq_u32 s[80:81], 12, v19
    v_cmp_eq_u32 s[82:83], 13, v19
    v_cmp_eq_u32 s[84:85], 14, v19
    v_cmp_eq_u32 s[86:87], 15, v19
    s_waitcnt lgkmcnt(0)
    s_mov_b32 s52, s44
    s_mov_b32 s53, s45
    s_mov_b32 s54, 22577152
    s_mov_b32 s55, 131072
    s_barrier
    ds_read_b64_tr_b16 v[96:97], v10 offset:0
    ds_read_b64_tr_b16 v[98:99], v10 offset:1024
    ds_read_b128 v[32:35], v9 offset:28672
    ds_read_b64_tr_b16 v[100:101], v10 offset:4096
    ds_read_b64_tr_b16 v[102:103], v10 offset:5120
    ds_read_b128 v[36:39], v9 offset:29696
    ds_read_b64_tr_b16 v[104:105], v10 offset:8192
    ds_read_b64_tr_b16 v[106:107], v10 offset:9216
    ds_read_b128 v[40:43], v9 offset:30720
    ds_read_b64_tr_b16 v[108:109], v10 offset:12288
    ds_read_b64_tr_b16 v[110:111], v10 offset:13312
    ds_read_b128 v[44:47], v9 offset:31744
    s_waitcnt lgkmcnt(0)
    s_barrier
    ds_read_b64_tr_b16 v[112:113], v10 offset:16384
    ds_read_b64_tr_b16 v[114:115], v10 offset:17408
    ds_read_b128 v[48:51], v9 offset:32768
    ds_read_b64_tr_b16 v[116:117], v10 offset:20480
    ds_read_b64_tr_b16 v[118:119], v10 offset:21504
    ds_read_b128 v[52:55], v9 offset:33792
    ds_read_b64_tr_b16 v[120:121], v10 offset:24576
    ds_read_b64_tr_b16 v[122:123], v10 offset:25600
    ds_read_b128 v[56:59], v9 offset:34816
    ds_read_b64_tr_b16 v[124:125], v10 offset:28672
    ds_read_b64_tr_b16 v[126:127], v10 offset:29696
    ds_read_b128 v[60:63], v9 offset:35840
    v_mfma_f32_32x32x16_bf16 v[208:223], v[32:35], v[96:99], 0
    v_mfma_f32_32x32x16_bf16 v[64:79], v[96:99], v[96:99], 0
    v_mfma_f32_32x32x16_bf16 v[80:95], v[14:17], v[96:99], 0
    v_mfma_f32_32x32x16_bf16 v[208:223], v[36:39], v[100:103], v[208:223]
    v_mfma_f32_32x32x16_bf16 v[64:79], v[100:103], v[100:103], v[64:79]
    v_mfma_f32_32x32x16_bf16 v[80:95], v[14:17], v[100:103], v[80:95]
    v_mfma_f32_32x32x16_bf16 v[208:223], v[40:43], v[104:107], v[208:223]
    v_mfma_f32_32x32x16_bf16 v[64:79], v[104:107], v[104:107], v[64:79]
    v_mfma_f32_32x32x16_bf16 v[80:95], v[14:17], v[104:107], v[80:95]
    v_mfma_f32_32x32x16_bf16 v[208:223], v[44:47], v[108:111], v[208:223]
    v_mfma_f32_32x32x16_bf16 v[64:79], v[108:111], v[108:111], v[64:79]
    v_mfma_f32_32x32x16_bf16 v[80:95], v[14:17], v[108:111], v[80:95]
    s_waitcnt lgkmcnt(0)
    s_barrier
    ds_read_b64_tr_b16 v[128:129], v10 offset:32768
    ds_read_b64_tr_b16 v[130:131], v10 offset:33792
    ds_read_b128 v[32:35], v9 offset:36864
    ds_read_b64_tr_b16 v[132:133], v10 offset:36864
    ds_read_b64_tr_b16 v[134:135], v10 offset:37888
    ds_read_b128 v[36:39], v9 offset:37888
    ds_read_b64_tr_b16 v[136:137], v10 offset:40960
    ds_read_b64_tr_b16 v[138:139], v10 offset:41984
    ds_read_b128 v[40:43], v9 offset:38912
    ds_read_b64_tr_b16 v[140:141], v10 offset:45056
    ds_read_b64_tr_b16 v[142:143], v10 offset:46080
    ds_read_b128 v[44:47], v9 offset:39936
    v_mfma_f32_32x32x16_bf16 v[208:223], v[48:51], v[112:115], v[208:223]
    v_mfma_f32_32x32x16_bf16 v[64:79], v[112:115], v[112:115], v[64:79]
    v_mfma_f32_32x32x16_bf16 v[80:95], v[14:17], v[112:115], v[80:95]
    v_mfma_f32_32x32x16_bf16 v[208:223], v[52:55], v[116:119], v[208:223]
    v_mfma_f32_32x32x16_bf16 v[64:79], v[116:119], v[116:119], v[64:79]
    v_mfma_f32_32x32x16_bf16 v[80:95], v[14:17], v[116:119], v[80:95]
    v_mfma_f32_32x32x16_bf16 v[208:223], v[56:59], v[120:123], v[208:223]
    v_mfma_f32_32x32x16_bf16 v[64:79], v[120:123], v[120:123], v[64:79]
    v_mfma_f32_32x32x16_bf16 v[80:95], v[14:17], v[120:123], v[80:95]
    v_mfma_f32_32x32x16_bf16 v[208:223], v[60:63], v[124:127], v[208:223]
    v_mfma_f32_32x32x16_bf16 v[64:79], v[124:127], v[124:127], v[64:79]
    v_mfma_f32_32x32x16_bf16 v[80:95], v[14:17], v[124:127], v[80:95]
    s_waitcnt lgkmcnt(0)
    s_barrier
    ds_read_b64_tr_b16 v[144:145], v10 offset:49152
    ds_read_b64_tr_b16 v[146:147], v10 offset:50176
    ds_read_b128 v[48:51], v9 offset:40960
    ds_read_b64_tr_b16 v[148:149], v10 offset:53248
    ds_read_b64_tr_b16 v[150:151], v10 offset:54272
    ds_read_b128 v[52:55], v9 offset:41984
    ds_read_b64_tr_b16 v[152:153], v10 offset:57344
    ds_read_b64_tr_b16 v[154:155], v10 offset:58368
    ds_read_b128 v[56:59], v9 offset:43008
    ds_read_b64_tr_b16 v[156:157], v10 offset:61440
    ds_read_b64_tr_b16 v[158:159], v10 offset:62464
    ds_read_b128 v[60:63], v9 offset:44032
    v_mfma_f32_32x32x16_bf16 v[208:223], v[32:35], v[128:131], v[208:223]
    v_mfma_f32_32x32x16_bf16 v[64:79], v[128:131], v[128:131], v[64:79]
    v_mfma_f32_32x32x16_bf16 v[80:95], v[14:17], v[128:131], v[80:95]
    v_mfma_f32_32x32x16_bf16 v[208:223], v[36:39], v[132:135], v[208:223]
    v_mfma_f32_32x32x16_bf16 v[64:79], v[132:135], v[132:135], v[64:79]
    v_mfma_f32_32x32x16_bf16 v[80:95], v[14:17], v[132:135], v[80:95]
    v_mfma_f32_32x32x16_bf16 v[208:223], v[40:43], v[136:139], v[208:223]
    v_mfma_f32_32x32x16_bf16 v[64:79], v[136:139], v[136:139], v[64:79]
    v_mfma_f32_32x32x16_bf16 v[80:95], v[14:17], v[136:139], v[80:95]
    v_mfma_f32_32x32x16_bf16 v[208:223], v[44:47], v[140:143], v[208:223]
    v_mfma_f32_32x32x16_bf16 v[64:79], v[140:143], v[140:143], v[64:79]
    v_mfma_f32_32x32x16_bf16 v[80:95], v[14:17], v[140:143], v[80:95]
    s_waitcnt lgkmcnt(0)
    s_barrier
    ds_read_b64_tr_b16 v[160:161], v11 offset:0
    ds_read_b64_tr_b16 v[162:163], v11 offset:1024
    ds_read_b128 v[32:35], v9 offset:45056
    ds_read_b64_tr_b16 v[164:165], v11 offset:4096
    ds_read_b64_tr_b16 v[166:167], v11 offset:5120
    ds_read_b128 v[36:39], v9 offset:46080
    ds_read_b64_tr_b16 v[168:169], v11 offset:8192
    ds_read_b64_tr_b16 v[170:171], v11 offset:9216
    ds_read_b128 v[40:43], v9 offset:47104
    ds_read_b64_tr_b16 v[172:173], v11 offset:12288
    ds_read_b64_tr_b16 v[174:175], v11 offset:13312
    ds_read_b128 v[44:47], v9 offset:48128
    v_mfma_f32_32x32x16_bf16 v[208:223], v[48:51], v[144:147], v[208:223]
    v_mfma_f32_32x32x16_bf16 v[64:79], v[144:147], v[144:147], v[64:79]
    v_mfma_f32_32x32x16_bf16 v[80:95], v[14:17], v[144:147], v[80:95]
    v_mfma_f32_32x32x16_bf16 v[208:223], v[52:55], v[148:151], v[208:223]
    v_mfma_f32_32x32x16_bf16 v[64:79], v[148:151], v[148:151], v[64:79]
    v_mfma_f32_32x32x16_bf16 v[80:95], v[14:17], v[148:151], v[80:95]
    v_mfma_f32_32x32x16_bf16 v[208:223], v[56:59], v[152:155], v[208:223]
    v_mfma_f32_32x32x16_bf16 v[64:79], v[152:155], v[152:155], v[64:79]
    v_mfma_f32_32x32x16_bf16 v[80:95], v[14:17], v[152:155], v[80:95]
    v_mfma_f32_32x32x16_bf16 v[208:223], v[60:63], v[156:159], v[208:223]
    v_mfma_f32_32x32x16_bf16 v[64:79], v[156:159], v[156:159], v[64:79]
    v_mfma_f32_32x32x16_bf16 v[80:95], v[14:17], v[156:159], v[80:95]
    s_waitcnt lgkmcnt(0)
    s_barrier
    ds_read_b64_tr_b16 v[176:177], v11 offset:16384
    ds_read_b64_tr_b16 v[178:179], v11 offset:17408
    ds_read_b128 v[48:51], v9 offset:49152
    ds_read_b64_tr_b16 v[180:181], v11 offset:20480
    ds_read_b64_tr_b16 v[182:183], v11 offset:21504
    ds_read_b128 v[52:55], v9 offset:50176
    ds_read_b64_tr_b16 v[184:185], v11 offset:24576
    ds_read_b64_tr_b16 v[186:187], v11 offset:25600
    ds_read_b128 v[56:59], v9 offset:51200
    ds_read_b64_tr_b16 v[188:189], v11 offset:28672
    ds_read_b64_tr_b16 v[190:191], v11 offset:29696
    ds_read_b128 v[60:63], v9 offset:52224
    v_mfma_f32_32x32x16_bf16 v[208:223], v[32:35], v[160:163], v[208:223]
    v_mfma_f32_32x32x16_bf16 v[64:79], v[160:163], v[160:163], v[64:79]
    v_mfma_f32_32x32x16_bf16 v[80:95], v[14:17], v[160:163], v[80:95]
    v_mfma_f32_32x32x16_bf16 v[208:223], v[36:39], v[164:167], v[208:223]
    v_mfma_f32_32x32x16_bf16 v[64:79], v[164:167], v[164:167], v[64:79]
    v_mfma_f32_32x32x16_bf16 v[80:95], v[14:17], v[164:167], v[80:95]
    v_mfma_f32_32x32x16_bf16 v[208:223], v[40:43], v[168:171], v[208:223]
    v_mfma_f32_32x32x16_bf16 v[64:79], v[168:171], v[168:171], v[64:79]
    v_mfma_f32_32x32x16_bf16 v[80:95], v[14:17], v[168:171], v[80:95]
    v_mfma_f32_32x32x16_bf16 v[208:223], v[44:47], v[172:175], v[208:223]
    v_mfma_f32_32x32x16_bf16 v[64:79], v[172:175], v[172:175], v[64:79]
    v_mfma_f32_32x32x16_bf16 v[80:95], v[14:17], v[172:175], v[80:95]
    s_waitcnt lgkmcnt(0)
    s_barrier
    ds_read_b64_tr_b16 v[192:193], v11 offset:32768
    ds_read_b64_tr_b16 v[194:195], v11 offset:33792
    ds_read_b128 v[32:35], v9 offset:53248
    ds_read_b64_tr_b16 v[196:197], v11 offset:36864
    ds_read_b64_tr_b16 v[198:199], v11 offset:37888
    ds_read_b128 v[36:39], v9 offset:54272
    ds_read_b64_tr_b16 v[200:201], v11 offset:40960
    ds_read_b64_tr_b16 v[202:203], v11 offset:41984
    ds_read_b128 v[40:43], v9 offset:55296
    ds_read_b64_tr_b16 v[204:205], v11 offset:45056
    ds_read_b64_tr_b16 v[206:207], v11 offset:46080
    ds_read_b128 v[44:47], v9 offset:56320
    v_mfma_f32_32x32x16_bf16 v[208:223], v[48:51], v[176:179], v[208:223]
    v_mfma_f32_32x32x16_bf16 v[64:79], v[176:179], v[176:179], v[64:79]
    v_mfma_f32_32x32x16_bf16 v[80:95], v[14:17], v[176:179], v[80:95]
    v_mfma_f32_32x32x16_bf16 v[208:223], v[52:55], v[180:183], v[208:223]
    v_mfma_f32_32x32x16_bf16 v[64:79], v[180:183], v[180:183], v[64:79]
    v_mfma_f32_32x32x16_bf16 v[80:95], v[14:17], v[180:183], v[80:95]
    v_mfma_f32_32x32x16_bf16 v[208:223], v[56:59], v[184:187], v[208:223]
    v_mfma_f32_32x32x16_bf16 v[64:79], v[184:187], v[184:187], v[64:79]
    v_mfma_f32_32x32x16_bf16 v[80:95], v[14:17], v[184:187], v[80:95]
    v_mfma_f32_32x32x16_bf16 v[208:223], v[60:63], v[188:191], v[208:223]
    v_mfma_f32_32x32x16_bf16 v[64:79], v[188:191], v[188:191], v[64:79]
    v_mfma_f32_32x32x16_bf16 v[80:95], v[14:17], v[188:191], v[80:95]
    s_waitcnt lgkmcnt(0)
    s_barrier
    s_setprio 2
    s_waitcnt vmcnt(0)
    ds_read_b128 v[48:51], v8 offset:0
    ds_read_b128 v[52:55], v8 offset:1024
    ds_read_b128 v[56:59], v8 offset:2048
    ds_read_b128 v[60:63], v8 offset:3072
    ds_read_b128 v[240:243], v8 offset:4096
    ds_read_b128 v[244:247], v8 offset:5120
    ds_read_b128 v[248:251], v8 offset:6144
    v_mfma_f32_32x32x16_bf16 v[208:223], v[32:35], v[192:195], v[208:223]
    v_mfma_f32_32x32x16_bf16 v[64:79], v[192:195], v[192:195], v[64:79]
    v_mfma_f32_32x32x16_bf16 v[80:95], v[14:17], v[192:195], v[80:95]
    v_mfma_f32_32x32x16_bf16 v[208:223], v[36:39], v[196:199], v[208:223]
    v_mfma_f32_32x32x16_bf16 v[64:79], v[196:199], v[196:199], v[64:79]
    v_mfma_f32_32x32x16_bf16 v[80:95], v[14:17], v[196:199], v[80:95]
    v_mfma_f32_32x32x16_bf16 v[208:223], v[40:43], v[200:203], v[208:223]
    v_mfma_f32_32x32x16_bf16 v[64:79], v[200:203], v[200:203], v[64:79]
    v_mfma_f32_32x32x16_bf16 v[80:95], v[14:17], v[200:203], v[80:95]
    v_mfma_f32_32x32x16_bf16 v[208:223], v[44:47], v[204:207], v[208:223]
    v_mfma_f32_32x32x16_bf16 v[64:79], v[204:207], v[204:207], v[64:79]
    v_mfma_f32_32x32x16_bf16 v[80:95], v[14:17], v[204:207], v[80:95]
    v_mov_b32 v16, 1
    v_lshlrev_b32 v17, 28, v1
    v_lshl_add_u32 v17, v1, 25, v17
    s_lshl_b32 s90, s3, 8
    s_add_u32 s90, s90, 6815744
    s_add_u32 s91, s90, 4096
    s_waitcnt lgkmcnt(6)
    v_mfma_f32_32x32x16_bf16 v[224:239], v[48:51], v[96:99], 0
    ds_read_b128 v[252:255], v8 offset:7168
    s_waitcnt lgkmcnt(6)
    v_mfma_f32_32x32x16_bf16 v[224:239], v[52:55], v[100:103], v[224:239]
    ds_read_b128 v[48:51], v8 offset:8192
    s_waitcnt lgkmcnt(6)
    v_mfma_f32_32x32x16_bf16 v[224:239], v[56:59], v[104:107], v[224:239]
    ds_read_b128 v[52:55], v8 offset:9216
    v_mov_b32 v23, 0
    v_cndmask_b32 v23, v23, v64, s[56:57]
    v_cndmask_b32 v23, v23, v65, s[58:59]
    s_waitcnt lgkmcnt(6)
    v_mfma_f32_32x32x16_bf16 v[224:239], v[60:63], v[108:111], v[224:239]
    ds_read_b128 v[56:59], v8 offset:10240
    v_cndmask_b32 v23, v23, v66, s[60:61]
    v_cndmask_b32 v23, v23, v67, s[62:63]
    v_cndmask_b32 v23, v23, v68, s[64:65]
    s_waitcnt lgkmcnt(6)
    v_mfma_f32_32x32x16_bf16 v[224:239], v[240:243], v[112:115], v[224:239]
    ds_read_b128 v[60:63], v8 offset:11264
    v_cndmask_b32 v23, v23, v69, s[66:67]
    v_cndmask_b32 v23, v23, v70, s[68:69]
    v_cndmask_b32 v23, v23, v71, s[70:71]
    s_waitcnt lgkmcnt(6)
    v_mfma_f32_32x32x16_bf16 v[224:239], v[244:247], v[116:119], v[224:239]
    ds_read_b128 v[240:243], v8 offset:12288
    v_cndmask_b32 v23, v23, v72, s[72:73]
    v_cndmask_b32 v23, v23, v73, s[74:75]
    v_cndmask_b32 v23, v23, v74, s[76:77]
    s_waitcnt lgkmcnt(6)
    v_mfma_f32_32x32x16_bf16 v[224:239], v[248:251], v[120:123], v[224:239]
    ds_read_b128 v[244:247], v8 offset:13312
    v_cndmask_b32 v23, v23, v75, s[78:79]
    v_cndmask_b32 v23, v23, v76, s[80:81]
    v_cndmask_b32 v23, v23, v77, s[82:83]
    s_waitcnt lgkmcnt(6)
    v_mfma_f32_32x32x16_bf16 v[224:239], v[252:255], v[124:127], v[224:239]
    ds_read_b128 v[248:251], v8 offset:14336
    v_cndmask_b32 v23, v23, v78, s[84:85]
    v_cndmask_b32 v23, v23, v79, s[86:87]
    v_mul_f32 v18, s8, v80
    s_waitcnt lgkmcnt(6)
    v_mfma_f32_32x32x16_bf16 v[224:239], v[48:51], v[128:131], v[224:239]
    ds_read_b128 v[252:255], v8 offset:15360
    ds_read_b128 v[64:67], v12 offset:0
    v_mov_b32 v25, v23
    s_nop 0
    s_waitcnt lgkmcnt(7)
    v_mfma_f32_32x32x16_bf16 v[224:239], v[52:55], v[132:135], v[224:239]
    ds_read_b128 v[48:51], v8 offset:16384
    v_permlane32_swap_b32 v25, v23
    v_add_f32 v23, v23, v25
    v_mul_f32 v19, s8, v23
    s_waitcnt lgkmcnt(7)
    v_mfma_f32_32x32x16_bf16 v[224:239], v[56:59], v[136:139], v[224:239]
    ds_read_b128 v[52:55], v8 offset:17408
    v_fma_f32 v19, -v18, v18, v19
    v_max_f32 v19, 0, v19
    v_cvt_pk_bf16_f32 v19, v19, v19
    s_waitcnt lgkmcnt(7)
    v_mfma_f32_32x32x16_bf16 v[224:239], v[60:63], v[140:143], v[224:239]
    ds_read_b128 v[56:59], v8 offset:18432
    v_lshlrev_b32 v19, 16, v19
    v_add_f32 v19, s9, v19
    v_cvt_pk_bf16_f32 v19, v19, v19
    s_waitcnt lgkmcnt(7)
    v_mfma_f32_32x32x16_bf16 v[224:239], v[240:243], v[144:147], v[224:239]
    ds_read_b128 v[60:63], v8 offset:19456
    v_lshlrev_b32 v19, 16, v19
    v_sqrt_f32 v26, v19
    s_waitcnt lgkmcnt(7)
    v_mfma_f32_32x32x16_bf16 v[224:239], v[244:247], v[148:151], v[224:239]
    ds_read_b128 v[240:243], v8 offset:20480
    v_sub_f32 v15, 0, v18
    v_cvt_pk_bf16_f32 v32, v26, v26
    v_cvt_pk_bf16_f32 v33, v15, v15
    s_waitcnt lgkmcnt(7)
    v_mfma_f32_32x32x16_bf16 v[224:239], v[248:251], v[152:155], v[224:239]
    ds_read_b128 v[244:247], v8 offset:21504
    v_lshlrev_b32 v26, 16, v32
    v_mov_b32 v34, 0
    v_mov_b32 v35, 0
    s_waitcnt lgkmcnt(7)
    v_mfma_f32_32x32x16_bf16 v[224:239], v[252:255], v[156:159], v[224:239]
    ds_read_b128 v[248:251], v8 offset:22528
    v_rcp_f32 v20, v26
    v_mul_f32 v27, v26, v26
    s_waitcnt lgkmcnt(6)
    v_mfma_f32_32x32x16_bf16 v[224:239], v[48:51], v[160:163], v[224:239]
    ds_read_b128 v[252:255], v8 offset:23552
    v_cndmask_b32 v32, 0, v32, s[88:89]
    v_cndmask_b32 v33, 0, v33, s[88:89]
    v_mul_f32 v14, s10, v20
    s_waitcnt lgkmcnt(6)
    v_mfma_f32_32x32x16_bf16 v[224:239], v[52:55], v[164:167], v[224:239]
    ds_read_b128 v[48:51], v8 offset:24576
    v_mfma_f32_32x32x16_bf16 v[208:223], v[64:67], v[32:35], v[208:223]
    ds_read_b128 v[68:71], v12 offset:1024
    s_waitcnt lgkmcnt(7)
    v_mfma_f32_32x32x16_bf16 v[224:239], v[56:59], v[168:171], v[224:239]
    ds_read_b128 v[52:55], v8 offset:25600
    s_waitcnt lgkmcnt(7)
    v_mfma_f32_32x32x16_bf16 v[224:239], v[60:63], v[172:175], v[224:239]
    ds_read_b128 v[56:59], v8 offset:26624
    s_waitcnt lgkmcnt(7)
    v_mfma_f32_32x32x16_bf16 v[224:239], v[240:243], v[176:179], v[224:239]
    ds_read_b128 v[60:63], v8 offset:27648
    s_waitcnt lgkmcnt(7)
    v_mfma_f32_32x32x16_bf16 v[224:239], v[244:247], v[180:183], v[224:239]
    s_waitcnt lgkmcnt(0)
    s_barrier
    ds_read_b128 v[240:243], v8 offset:32768
    v_mul_f32 v40, v14, v208
    v_mul_f32 v41, v14, v209
    v_mul_f32 v42, v14, v210
    v_mfma_f32_32x32x16_bf16 v[224:239], v[248:251], v[184:187], v[224:239]
    ds_read_b128 v[244:247], v8 offset:33792
    v_mul_f32 v43, v14, v211
    v_mul_f32 v44, v14, v212
    v_mul_f32 v45, v14, v213
    v_mfma_f32_32x32x16_bf16 v[224:239], v[252:255], v[188:191], v[224:239]
    ds_read_b128 v[248:251], v8 offset:34816
    v_mul_f32 v46, v14, v214
    v_mul_f32 v47, v14, v215
    v_exp_f32 v40, v40
    v_mfma_f32_32x32x16_bf16 v[224:239], v[48:51], v[192:195], v[224:239]
    ds_read_b128 v[252:255], v8 offset:35840
    v_mul_f32 v208, v208, v216
    v_exp_f32 v41, v41
    v_mfma_f32_32x32x16_bf16 v[224:239], v[52:55], v[196:199], v[224:239]
    ds_read_b128 v[48:51], v8 offset:36864
    v_mul_f32 v209, v209, v217
    v_exp_f32 v42, v42
    v_mfma_f32_32x32x16_bf16 v[224:239], v[56:59], v[200:203], v[224:239]
    ds_read_b128 v[52:55], v8 offset:37888
    v_mul_f32 v210, v210, v218
    v_exp_f32 v43, v43
    v_mfma_f32_32x32x16_bf16 v[224:239], v[60:63], v[204:207], v[224:239]
    ds_read_b128 v[56:59], v8 offset:38912
    v_mfma_f32_32x32x16_bf16 v[224:239], v[68:71], v[32:35], v[224:239]
    ds_read_b128 v[64:67], v12 offset:2048
    v_mul_f32 v211, v211, v219
    v_exp_f32 v44, v44
    v_mul_f32 v212, v212, v220
    v_exp_f32 v45, v45
    v_mul_f32 v213, v213, v221
    v_exp_f32 v46, v46
    v_mul_f32 v214, v214, v222
    v_exp_f32 v47, v47
    v_mul_f32 v215, v215, v223
    v_fma_f32 v40, v40, v27, v27
    v_fma_f32 v41, v41, v27, v27
    v_fma_f32 v42, v42, v27, v27
    v_fma_f32 v43, v43, v27, v27
    v_fma_f32 v44, v44, v27, v27
    v_fma_f32 v45, v45, v27, v27
    v_fma_f32 v46, v46, v27, v27
    v_fma_f32 v47, v47, v27, v27
    v_rcp_f32 v40, v40
    v_rcp_f32 v41, v41
    v_rcp_f32 v42, v42
    v_rcp_f32 v43, v43
    v_rcp_f32 v44, v44
    v_rcp_f32 v45, v45
    v_rcp_f32 v46, v46
    v_rcp_f32 v47, v47
    v_mul_f32 v208, v208, v40
    v_mul_f32 v209, v209, v41
    v_mul_f32 v210, v210, v42
    v_mul_f32 v211, v211, v43
    v_mul_f32 v212, v212, v44
    v_mul_f32 v213, v213, v45
    v_mul_f32 v214, v214, v46
    v_mul_f32 v215, v215, v47
    v_cvt_pk_bf16_f32 v28, v208, v209
    v_cvt_pk_bf16_f32 v29, v210, v211
    v_cvt_pk_bf16_f32 v30, v212, v213
    v_cvt_pk_bf16_f32 v31, v214, v215
    s_add_u32 s13, s7, 0
    buffer_store_dwordx4 v[28:31], v13, s[52:55], s13 offen sc1
    s_waitcnt lgkmcnt(7)
    v_mfma_f32_32x32x16_bf16 v[208:223], v[240:243], v[96:99], 0
    ds_read_b128 v[60:63], v8 offset:39936
    s_waitcnt lgkmcnt(7)
    v_mfma_f32_32x32x16_bf16 v[208:223], v[244:247], v[100:103], v[208:223]
    ds_read_b128 v[240:243], v8 offset:40960
    s_waitcnt lgkmcnt(7)
    v_mfma_f32_32x32x16_bf16 v[208:223], v[248:251], v[104:107], v[208:223]
    ds_read_b128 v[244:247], v8 offset:41984
    v_mul_f32 v40, v14, v224
    v_mul_f32 v41, v14, v225
    v_mul_f32 v42, v14, v226
    s_waitcnt lgkmcnt(7)
    v_mfma_f32_32x32x16_bf16 v[208:223], v[252:255], v[108:111], v[208:223]
    ds_read_b128 v[248:251], v8 offset:43008
    v_mul_f32 v43, v14, v227
    v_mul_f32 v44, v14, v228
    v_mul_f32 v45, v14, v229
    s_waitcnt lgkmcnt(7)
    v_mfma_f32_32x32x16_bf16 v[208:223], v[48:51], v[112:115], v[208:223]
    ds_read_b128 v[252:255], v8 offset:44032
    v_mul_f32 v46, v14, v230
    v_mul_f32 v47, v14, v231
    v_exp_f32 v40, v40
    s_waitcnt lgkmcnt(7)
    v_mfma_f32_32x32x16_bf16 v[208:223], v[52:55], v[116:119], v[208:223]
    ds_read_b128 v[48:51], v8 offset:45056
    v_mul_f32 v224, v224, v232
    v_exp_f32 v41, v41
    s_waitcnt lgkmcnt(7)
    v_mfma_f32_32x32x16_bf16 v[208:223], v[56:59], v[120:123], v[208:223]
    ds_read_b128 v[52:55], v8 offset:46080
    v_mul_f32 v225, v225, v233
    v_exp_f32 v42, v42
    s_waitcnt lgkmcnt(6)
    v_mfma_f32_32x32x16_bf16 v[208:223], v[60:63], v[124:127], v[208:223]
    ds_read_b128 v[56:59], v8 offset:47104
    v_mul_f32 v226, v226, v234
    v_exp_f32 v43, v43
    s_waitcnt lgkmcnt(6)
    v_mfma_f32_32x32x16_bf16 v[208:223], v[240:243], v[128:131], v[208:223]
    ds_read_b128 v[60:63], v8 offset:48128
    v_mul_f32 v227, v227, v235
    v_exp_f32 v44, v44
    s_waitcnt lgkmcnt(6)
    v_mfma_f32_32x32x16_bf16 v[208:223], v[244:247], v[132:135], v[208:223]
    ds_read_b128 v[240:243], v8 offset:49152
    v_mul_f32 v228, v228, v236
    v_exp_f32 v45, v45
    s_waitcnt lgkmcnt(6)
    v_mfma_f32_32x32x16_bf16 v[208:223], v[248:251], v[136:139], v[208:223]
    ds_read_b128 v[244:247], v8 offset:50176
    v_mul_f32 v229, v229, v237
    v_exp_f32 v46, v46
    s_waitcnt lgkmcnt(6)
    v_mfma_f32_32x32x16_bf16 v[208:223], v[252:255], v[140:143], v[208:223]
    ds_read_b128 v[248:251], v8 offset:51200
    v_mul_f32 v230, v230, v238
    v_exp_f32 v47, v47
    s_waitcnt lgkmcnt(6)
    v_mfma_f32_32x32x16_bf16 v[208:223], v[48:51], v[144:147], v[208:223]
    ds_read_b128 v[252:255], v8 offset:52224
    v_mul_f32 v231, v231, v239
    v_fma_f32 v40, v40, v27, v27
    v_fma_f32 v41, v41, v27, v27
    s_waitcnt lgkmcnt(6)
    v_mfma_f32_32x32x16_bf16 v[208:223], v[52:55], v[148:151], v[208:223]
    ds_read_b128 v[48:51], v8 offset:53248
    v_fma_f32 v42, v42, v27, v27
    v_fma_f32 v43, v43, v27, v27
    v_fma_f32 v44, v44, v27, v27
    s_waitcnt lgkmcnt(6)
    v_mfma_f32_32x32x16_bf16 v[208:223], v[56:59], v[152:155], v[208:223]
    ds_read_b128 v[52:55], v8 offset:54272
    v_fma_f32 v45, v45, v27, v27
    v_fma_f32 v46, v46, v27, v27
    v_fma_f32 v47, v47, v27, v27
    s_waitcnt lgkmcnt(6)
    v_mfma_f32_32x32x16_bf16 v[208:223], v[60:63], v[156:159], v[208:223]
    ds_read_b128 v[56:59], v8 offset:55296
    v_rcp_f32 v40, v40
    v_rcp_f32 v41, v41
    s_waitcnt lgkmcnt(6)
    v_mfma_f32_32x32x16_bf16 v[208:223], v[240:243], v[160:163], v[208:223]
    ds_read_b128 v[60:63], v8 offset:56320
    v_rcp_f32 v42, v42
    v_rcp_f32 v43, v43
    s_waitcnt lgkmcnt(6)
    v_mfma_f32_32x32x16_bf16 v[208:223], v[244:247], v[164:167], v[208:223]
    ds_read_b128 v[240:243], v8 offset:57344
    v_rcp_f32 v44, v44
    v_rcp_f32 v45, v45
    s_waitcnt lgkmcnt(6)
    v_mfma_f32_32x32x16_bf16 v[208:223], v[248:251], v[168:171], v[208:223]
    ds_read_b128 v[244:247], v8 offset:58368
    v_rcp_f32 v46, v46
    v_rcp_f32 v47, v47
    s_waitcnt lgkmcnt(6)
    v_mfma_f32_32x32x16_bf16 v[208:223], v[252:255], v[172:175], v[208:223]
    ds_read_b128 v[248:251], v8 offset:59392
    v_mul_f32 v224, v224, v40
    v_mul_f32 v225, v225, v41
    v_mul_f32 v226, v226, v42
    s_waitcnt lgkmcnt(6)
    v_mfma_f32_32x32x16_bf16 v[208:223], v[48:51], v[176:179], v[208:223]
    ds_read_b128 v[252:255], v8 offset:60416
    v_mul_f32 v227, v227, v43
    v_mul_f32 v228, v228, v44
    v_mul_f32 v229, v229, v45
    s_waitcnt lgkmcnt(6)
    v_mfma_f32_32x32x16_bf16 v[208:223], v[52:55], v[180:183], v[208:223]
    ds_read_b128 v[48:51], v3 offset:0
    v_mul_f32 v230, v230, v46
    v_mul_f32 v231, v231, v47
    v_cvt_pk_bf16_f32 v28, v224, v225
    s_waitcnt lgkmcnt(6)
    v_mfma_f32_32x32x16_bf16 v[208:223], v[56:59], v[184:187], v[208:223]
    ds_read_b128 v[52:55], v3 offset:1024
    v_cvt_pk_bf16_f32 v29, v226, v227
    v_cvt_pk_bf16_f32 v30, v228, v229
    v_cvt_pk_bf16_f32 v31, v230, v231
    s_waitcnt lgkmcnt(6)
    v_mfma_f32_32x32x16_bf16 v[208:223], v[60:63], v[188:191], v[208:223]
    ds_read_b128 v[56:59], v3 offset:2048
    s_add_u32 s13, s7, 67584
    buffer_store_dwordx4 v[28:31], v13, s[52:55], s13 offen sc1
    s_waitcnt lgkmcnt(6)
    v_mfma_f32_32x32x16_bf16 v[208:223], v[240:243], v[192:195], v[208:223]
    ds_read_b128 v[60:63], v3 offset:3072
    s_waitcnt lgkmcnt(6)
    v_mfma_f32_32x32x16_bf16 v[208:223], v[244:247], v[196:199], v[208:223]
    ds_read_b128 v[240:243], v3 offset:4096
    s_waitcnt lgkmcnt(6)
    v_mfma_f32_32x32x16_bf16 v[208:223], v[248:251], v[200:203], v[208:223]
    ds_read_b128 v[244:247], v3 offset:5120
    s_waitcnt lgkmcnt(6)
    v_mfma_f32_32x32x16_bf16 v[208:223], v[252:255], v[204:207], v[208:223]
    ds_read_b128 v[248:251], v3 offset:6144
    v_mfma_f32_32x32x16_bf16 v[208:223], v[64:67], v[32:35], v[208:223]
    ds_read_b128 v[68:71], v12 offset:3072
    s_waitcnt lgkmcnt(7)
    v_mfma_f32_32x32x16_bf16 v[224:239], v[48:51], v[96:99], 0
    ds_read_b128 v[252:255], v3 offset:7168
    s_waitcnt lgkmcnt(7)
    v_mfma_f32_32x32x16_bf16 v[224:239], v[52:55], v[100:103], v[224:239]
    ds_read_b128 v[48:51], v3 offset:8192
    s_waitcnt lgkmcnt(7)
    v_mfma_f32_32x32x16_bf16 v[224:239], v[56:59], v[104:107], v[224:239]
    ds_read_b128 v[52:55], v3 offset:9216
    s_nop 1
    v_mul_f32 v40, v14, v208
    v_mul_f32 v41, v14, v209
    v_mul_f32 v42, v14, v210
    s_waitcnt lgkmcnt(7)
    v_mfma_f32_32x32x16_bf16 v[224:239], v[60:63], v[108:111], v[224:239]
    ds_read_b128 v[56:59], v3 offset:10240
    v_mul_f32 v43, v14, v211
    v_mul_f32 v44, v14, v212
    v_mul_f32 v45, v14, v213
    s_waitcnt lgkmcnt(7)
    v_mfma_f32_32x32x16_bf16 v[224:239], v[240:243], v[112:115], v[224:239]
    ds_read_b128 v[60:63], v3 offset:11264
    v_mul_f32 v46, v14, v214
    v_mul_f32 v47, v14, v215
    v_exp_f32 v40, v40
    s_waitcnt lgkmcnt(7)
    v_mfma_f32_32x32x16_bf16 v[224:239], v[244:247], v[116:119], v[224:239]
    ds_read_b128 v[240:243], v3 offset:12288
    v_mul_f32 v208, v208, v216
    v_exp_f32 v41, v41
    s_waitcnt lgkmcnt(7)
    v_mfma_f32_32x32x16_bf16 v[224:239], v[248:251], v[120:123], v[224:239]
    ds_read_b128 v[244:247], v3 offset:13312
    v_mul_f32 v209, v209, v217
    v_exp_f32 v42, v42
    s_waitcnt lgkmcnt(6)
    v_mfma_f32_32x32x16_bf16 v[224:239], v[252:255], v[124:127], v[224:239]
    ds_read_b128 v[248:251], v3 offset:14336
    v_mul_f32 v210, v210, v218
    v_exp_f32 v43, v43
    s_waitcnt lgkmcnt(6)
    v_mfma_f32_32x32x16_bf16 v[224:239], v[48:51], v[128:131], v[224:239]
    ds_read_b128 v[252:255], v3 offset:15360
    v_mul_f32 v211, v211, v219
    v_exp_f32 v44, v44
    s_waitcnt lgkmcnt(6)
    v_mfma_f32_32x32x16_bf16 v[224:239], v[52:55], v[132:135], v[224:239]
    ds_read_b128 v[48:51], v3 offset:16384
    v_mul_f32 v212, v212, v220
    v_exp_f32 v45, v45
    s_waitcnt lgkmcnt(6)
    v_mfma_f32_32x32x16_bf16 v[224:239], v[56:59], v[136:139], v[224:239]
    ds_read_b128 v[52:55], v3 offset:17408
    v_mul_f32 v213, v213, v221
    v_exp_f32 v46, v46
    s_waitcnt lgkmcnt(6)
    v_mfma_f32_32x32x16_bf16 v[224:239], v[60:63], v[140:143], v[224:239]
    ds_read_b128 v[56:59], v3 offset:18432
    v_mul_f32 v214, v214, v222
    v_exp_f32 v47, v47
    s_waitcnt lgkmcnt(6)
    v_mfma_f32_32x32x16_bf16 v[224:239], v[240:243], v[144:147], v[224:239]
    ds_read_b128 v[60:63], v3 offset:19456
    v_mul_f32 v215, v215, v223
    v_fma_f32 v40, v40, v27, v27
    v_fma_f32 v41, v41, v27, v27
    s_waitcnt lgkmcnt(6)
    v_mfma_f32_32x32x16_bf16 v[224:239], v[244:247], v[148:151], v[224:239]
    ds_read_b128 v[240:243], v3 offset:20480
    v_fma_f32 v42, v42, v27, v27
    v_fma_f32 v43, v43, v27, v27
    v_fma_f32 v44, v44, v27, v27
    s_waitcnt lgkmcnt(6)
    v_mfma_f32_32x32x16_bf16 v[224:239], v[248:251], v[152:155], v[224:239]
    ds_read_b128 v[244:247], v3 offset:21504
    v_fma_f32 v45, v45, v27, v27
    v_fma_f32 v46, v46, v27, v27
    v_fma_f32 v47, v47, v27, v27
    s_waitcnt lgkmcnt(6)
    v_mfma_f32_32x32x16_bf16 v[224:239], v[252:255], v[156:159], v[224:239]
    ds_read_b128 v[248:251], v3 offset:22528
    v_rcp_f32 v40, v40
    v_rcp_f32 v41, v41
    s_waitcnt lgkmcnt(6)
    v_mfma_f32_32x32x16_bf16 v[224:239], v[48:51], v[160:163], v[224:239]
    ds_read_b128 v[252:255], v3 offset:23552
    v_rcp_f32 v42, v42
    v_rcp_f32 v43, v43
    s_waitcnt lgkmcnt(6)
    v_mfma_f32_32x32x16_bf16 v[224:239], v[52:55], v[164:167], v[224:239]
    ds_read_b128 v[48:51], v3 offset:24576
    v_rcp_f32 v44, v44
    v_rcp_f32 v45, v45
    s_waitcnt lgkmcnt(6)
    v_mfma_f32_32x32x16_bf16 v[224:239], v[56:59], v[168:171], v[224:239]
    ds_read_b128 v[52:55], v3 offset:25600
    v_rcp_f32 v46, v46
    v_rcp_f32 v47, v47
    s_waitcnt lgkmcnt(6)
    v_mfma_f32_32x32x16_bf16 v[224:239], v[60:63], v[172:175], v[224:239]
    ds_read_b128 v[56:59], v3 offset:26624
    v_mul_f32 v208, v208, v40
    v_mul_f32 v209, v209, v41
    v_mul_f32 v210, v210, v42
    s_waitcnt lgkmcnt(6)
    v_mfma_f32_32x32x16_bf16 v[224:239], v[240:243], v[176:179], v[224:239]
    ds_read_b128 v[60:63], v3 offset:27648
    v_mul_f32 v211, v211, v43
    v_mul_f32 v212, v212, v44
    v_mul_f32 v213, v213, v45
    s_waitcnt lgkmcnt(6)
    v_mfma_f32_32x32x16_bf16 v[224:239], v[244:247], v[180:183], v[224:239]
    s_waitcnt lgkmcnt(0)
    s_barrier
    ds_read_b128 v[240:243], v9 offset:0
    v_mul_f32 v214, v214, v46
    v_mul_f32 v215, v215, v47
    v_cvt_pk_bf16_f32 v28, v208, v209
    v_mfma_f32_32x32x16_bf16 v[224:239], v[248:251], v[184:187], v[224:239]
    ds_read_b128 v[244:247], v9 offset:1024
    v_cvt_pk_bf16_f32 v29, v210, v211
    v_cvt_pk_bf16_f32 v30, v212, v213
    v_cvt_pk_bf16_f32 v31, v214, v215
    v_mfma_f32_32x32x16_bf16 v[224:239], v[252:255], v[188:191], v[224:239]
    ds_read_b128 v[248:251], v9 offset:2048
    s_add_u32 s13, s7, 135168
    buffer_store_dwordx4 v[28:31], v13, s[52:55], s13 offen sc1
    v_mfma_f32_32x32x16_bf16 v[224:239], v[48:51], v[192:195], v[224:239]
    ds_read_b128 v[252:255], v9 offset:3072
    v_mfma_f32_32x32x16_bf16 v[224:239], v[52:55], v[196:199], v[224:239]
    ds_read_b128 v[48:51], v9 offset:4096
    v_mfma_f32_32x32x16_bf16 v[224:239], v[56:59], v[200:203], v[224:239]
    ds_read_b128 v[52:55], v9 offset:5120
    v_mfma_f32_32x32x16_bf16 v[224:239], v[60:63], v[204:207], v[224:239]
    ds_read_b128 v[56:59], v9 offset:6144
    v_mfma_f32_32x32x16_bf16 v[224:239], v[68:71], v[32:35], v[224:239]
    ds_read_b128 v[64:67], v12 offset:4096
    s_waitcnt lgkmcnt(7)
    v_mfma_f32_32x32x16_bf16 v[208:223], v[240:243], v[96:99], 0
    ds_read_b128 v[60:63], v9 offset:7168
    s_waitcnt lgkmcnt(7)
    v_mfma_f32_32x32x16_bf16 v[208:223], v[244:247], v[100:103], v[208:223]
    ds_read_b128 v[240:243], v9 offset:8192
    s_waitcnt lgkmcnt(7)
    v_mfma_f32_32x32x16_bf16 v[208:223], v[248:251], v[104:107], v[208:223]
    ds_read_b128 v[244:247], v9 offset:9216
    s_nop 1
    v_mul_f32 v40, v14, v224
    v_mul_f32 v41, v14, v225
    v_mul_f32 v42, v14, v226
    s_waitcnt lgkmcnt(7)
    v_mfma_f32_32x32x16_bf16 v[208:223], v[252:255], v[108:111], v[208:223]
    ds_read_b128 v[248:251], v9 offset:10240
    v_mul_f32 v43, v14, v227
    v_mul_f32 v44, v14, v228
    v_mul_f32 v45, v14, v229
    s_waitcnt lgkmcnt(7)
    v_mfma_f32_32x32x16_bf16 v[208:223], v[48:51], v[112:115], v[208:223]
    ds_read_b128 v[252:255], v9 offset:11264
    v_mul_f32 v46, v14, v230
    v_mul_f32 v47, v14, v231
    v_exp_f32 v40, v40
    s_waitcnt lgkmcnt(7)
    v_mfma_f32_32x32x16_bf16 v[208:223], v[52:55], v[116:119], v[208:223]
    ds_read_b128 v[48:51], v9 offset:12288
    v_mul_f32 v224, v224, v232
    v_exp_f32 v41, v41
    s_waitcnt lgkmcnt(7)
    v_mfma_f32_32x32x16_bf16 v[208:223], v[56:59], v[120:123], v[208:223]
    ds_read_b128 v[52:55], v9 offset:13312
    v_mul_f32 v225, v225, v233
    v_exp_f32 v42, v42
    s_waitcnt lgkmcnt(6)
    v_mfma_f32_32x32x16_bf16 v[208:223], v[60:63], v[124:127], v[208:223]
    ds_read_b128 v[56:59], v9 offset:14336
    v_mul_f32 v226, v226, v234
    v_exp_f32 v43, v43
    s_waitcnt lgkmcnt(6)
    v_mfma_f32_32x32x16_bf16 v[208:223], v[240:243], v[128:131], v[208:223]
    ds_read_b128 v[60:63], v9 offset:15360
    v_mul_f32 v227, v227, v235
    v_exp_f32 v44, v44
    s_waitcnt lgkmcnt(6)
    v_mfma_f32_32x32x16_bf16 v[208:223], v[244:247], v[132:135], v[208:223]
    ds_read_b128 v[240:243], v9 offset:16384
    v_mul_f32 v228, v228, v236
    v_exp_f32 v45, v45
    s_waitcnt lgkmcnt(6)
    v_mfma_f32_32x32x16_bf16 v[208:223], v[248:251], v[136:139], v[208:223]
    ds_read_b128 v[244:247], v9 offset:17408
    v_mul_f32 v229, v229, v237
    v_exp_f32 v46, v46
    s_waitcnt lgkmcnt(6)
    v_mfma_f32_32x32x16_bf16 v[208:223], v[252:255], v[140:143], v[208:223]
    ds_read_b128 v[248:251], v9 offset:18432
    v_mul_f32 v230, v230, v238
    v_exp_f32 v47, v47
    s_waitcnt lgkmcnt(6)
    v_mfma_f32_32x32x16_bf16 v[208:223], v[48:51], v[144:147], v[208:223]
    ds_read_b128 v[252:255], v9 offset:19456
    v_mul_f32 v231, v231, v239
    v_fma_f32 v40, v40, v27, v27
    v_fma_f32 v41, v41, v27, v27
    s_waitcnt lgkmcnt(6)
    v_mfma_f32_32x32x16_bf16 v[208:223], v[52:55], v[148:151], v[208:223]
    ds_read_b128 v[48:51], v9 offset:20480
    v_fma_f32 v42, v42, v27, v27
    v_fma_f32 v43, v43, v27, v27
    v_fma_f32 v44, v44, v27, v27
    s_waitcnt lgkmcnt(6)
    v_mfma_f32_32x32x16_bf16 v[208:223], v[56:59], v[152:155], v[208:223]
    ds_read_b128 v[52:55], v9 offset:21504
    v_fma_f32 v45, v45, v27, v27
    v_fma_f32 v46, v46, v27, v27
    v_fma_f32 v47, v47, v27, v27
    s_waitcnt lgkmcnt(6)
    v_mfma_f32_32x32x16_bf16 v[208:223], v[60:63], v[156:159], v[208:223]
    ds_read_b128 v[56:59], v9 offset:22528
    v_rcp_f32 v40, v40
    v_rcp_f32 v41, v41
    s_waitcnt lgkmcnt(6)
    v_mfma_f32_32x32x16_bf16 v[208:223], v[240:243], v[160:163], v[208:223]
    ds_read_b128 v[60:63], v9 offset:23552
    v_rcp_f32 v42, v42
    v_rcp_f32 v43, v43
    s_waitcnt lgkmcnt(6)
    v_mfma_f32_32x32x16_bf16 v[208:223], v[244:247], v[164:167], v[208:223]
    ds_read_b128 v[240:243], v9 offset:24576
    v_rcp_f32 v44, v44
    v_rcp_f32 v45, v45
    s_waitcnt lgkmcnt(6)
    v_mfma_f32_32x32x16_bf16 v[208:223], v[248:251], v[168:171], v[208:223]
    ds_read_b128 v[244:247], v9 offset:25600
    v_rcp_f32 v46, v46
    v_rcp_f32 v47, v47
    s_waitcnt lgkmcnt(6)
    v_mfma_f32_32x32x16_bf16 v[208:223], v[252:255], v[172:175], v[208:223]
    ds_read_b128 v[248:251], v9 offset:26624
    v_mul_f32 v224, v224, v40
    v_mul_f32 v225, v225, v41
    v_mul_f32 v226, v226, v42
    s_waitcnt lgkmcnt(6)
    v_mfma_f32_32x32x16_bf16 v[208:223], v[48:51], v[176:179], v[208:223]
    ds_read_b128 v[252:255], v9 offset:27648
    v_mul_f32 v227, v227, v43
    v_mul_f32 v228, v228, v44
    v_mul_f32 v229, v229, v45
    s_waitcnt lgkmcnt(6)
    v_mfma_f32_32x32x16_bf16 v[208:223], v[52:55], v[180:183], v[208:223]
    ds_read_b128 v[48:51], v9 offset:28672
    v_mul_f32 v230, v230, v46
    v_mul_f32 v231, v231, v47
    v_cvt_pk_bf16_f32 v28, v224, v225
    s_waitcnt lgkmcnt(6)
    v_mfma_f32_32x32x16_bf16 v[208:223], v[56:59], v[184:187], v[208:223]
    ds_read_b128 v[52:55], v9 offset:29696
    v_cvt_pk_bf16_f32 v29, v226, v227
    v_cvt_pk_bf16_f32 v30, v228, v229
    v_cvt_pk_bf16_f32 v31, v230, v231
    s_waitcnt lgkmcnt(6)
    v_mfma_f32_32x32x16_bf16 v[208:223], v[60:63], v[188:191], v[208:223]
    ds_read_b128 v[56:59], v9 offset:30720
    s_add_u32 s13, s7, 202752
    buffer_store_dwordx4 v[28:31], v13, s[52:55], s13 offen sc1
    s_waitcnt lgkmcnt(6)
    v_mfma_f32_32x32x16_bf16 v[208:223], v[240:243], v[192:195], v[208:223]
    ds_read_b128 v[60:63], v9 offset:31744
    s_waitcnt lgkmcnt(6)
    v_mfma_f32_32x32x16_bf16 v[208:223], v[244:247], v[196:199], v[208:223]
    ds_read_b128 v[240:243], v9 offset:32768
    s_waitcnt lgkmcnt(6)
    v_mfma_f32_32x32x16_bf16 v[208:223], v[248:251], v[200:203], v[208:223]
    ds_read_b128 v[244:247], v9 offset:33792
    s_waitcnt lgkmcnt(6)
    v_mfma_f32_32x32x16_bf16 v[208:223], v[252:255], v[204:207], v[208:223]
    ds_read_b128 v[248:251], v9 offset:34816
    v_mfma_f32_32x32x16_bf16 v[208:223], v[64:67], v[32:35], v[208:223]
    ds_read_b128 v[68:71], v12 offset:5120
    s_waitcnt lgkmcnt(7)
    v_mfma_f32_32x32x16_bf16 v[224:239], v[48:51], v[96:99], 0
    ds_read_b128 v[252:255], v9 offset:35840
    s_waitcnt lgkmcnt(7)
    v_mfma_f32_32x32x16_bf16 v[224:239], v[52:55], v[100:103], v[224:239]
    ds_read_b128 v[48:51], v9 offset:36864
    s_waitcnt lgkmcnt(7)
    v_mfma_f32_32x32x16_bf16 v[224:239], v[56:59], v[104:107], v[224:239]
    ds_read_b128 v[52:55], v9 offset:37888
    s_nop 1
    v_mul_f32 v40, v14, v208
    v_mul_f32 v41, v14, v209
    v_mul_f32 v42, v14, v210
    s_waitcnt lgkmcnt(7)
    v_mfma_f32_32x32x16_bf16 v[224:239], v[60:63], v[108:111], v[224:239]
    ds_read_b128 v[56:59], v9 offset:38912
    v_mul_f32 v43, v14, v211
    v_mul_f32 v44, v14, v212
    v_mul_f32 v45, v14, v213
    s_waitcnt lgkmcnt(7)
    v_mfma_f32_32x32x16_bf16 v[224:239], v[240:243], v[112:115], v[224:239]
    ds_read_b128 v[60:63], v9 offset:39936
    v_mul_f32 v46, v14, v214
    v_mul_f32 v47, v14, v215
    v_exp_f32 v40, v40
    s_waitcnt lgkmcnt(7)
    v_mfma_f32_32x32x16_bf16 v[224:239], v[244:247], v[116:119], v[224:239]
    ds_read_b128 v[240:243], v9 offset:40960
    v_mul_f32 v208, v208, v216
    v_exp_f32 v41, v41
    s_waitcnt lgkmcnt(7)
    v_mfma_f32_32x32x16_bf16 v[224:239], v[248:251], v[120:123], v[224:239]
    ds_read_b128 v[244:247], v9 offset:41984
    v_mul_f32 v209, v209, v217
    v_exp_f32 v42, v42
    s_waitcnt lgkmcnt(6)
    v_mfma_f32_32x32x16_bf16 v[224:239], v[252:255], v[124:127], v[224:239]
    ds_read_b128 v[248:251], v9 offset:43008
    v_mul_f32 v210, v210, v218
    v_exp_f32 v43, v43
    s_waitcnt lgkmcnt(6)
    v_mfma_f32_32x32x16_bf16 v[224:239], v[48:51], v[128:131], v[224:239]
    ds_read_b128 v[252:255], v9 offset:44032
    v_mul_f32 v211, v211, v219
    v_exp_f32 v44, v44
    s_waitcnt lgkmcnt(6)
    v_mfma_f32_32x32x16_bf16 v[224:239], v[52:55], v[132:135], v[224:239]
    ds_read_b128 v[48:51], v9 offset:45056
    v_mul_f32 v212, v212, v220
    v_exp_f32 v45, v45
    s_waitcnt lgkmcnt(6)
    v_mfma_f32_32x32x16_bf16 v[224:239], v[56:59], v[136:139], v[224:239]
    ds_read_b128 v[52:55], v9 offset:46080
    v_mul_f32 v213, v213, v221
    v_exp_f32 v46, v46
    s_waitcnt lgkmcnt(6)
    v_mfma_f32_32x32x16_bf16 v[224:239], v[60:63], v[140:143], v[224:239]
    ds_read_b128 v[56:59], v9 offset:47104
    v_mul_f32 v214, v214, v222
    v_exp_f32 v47, v47
    s_waitcnt lgkmcnt(6)
    v_mfma_f32_32x32x16_bf16 v[224:239], v[240:243], v[144:147], v[224:239]
    ds_read_b128 v[60:63], v9 offset:48128
    v_mul_f32 v215, v215, v223
    v_fma_f32 v40, v40, v27, v27
    v_fma_f32 v41, v41, v27, v27
    s_waitcnt lgkmcnt(6)
    v_mfma_f32_32x32x16_bf16 v[224:239], v[244:247], v[148:151], v[224:239]
    ds_read_b128 v[240:243], v9 offset:49152
    v_fma_f32 v42, v42, v27, v27
    v_fma_f32 v43, v43, v27, v27
    v_fma_f32 v44, v44, v27, v27
    s_waitcnt lgkmcnt(6)
    v_mfma_f32_32x32x16_bf16 v[224:239], v[248:251], v[152:155], v[224:239]
    ds_read_b128 v[244:247], v9 offset:50176
    v_fma_f32 v45, v45, v27, v27
    v_fma_f32 v46, v46, v27, v27
    v_fma_f32 v47, v47, v27, v27
    s_waitcnt lgkmcnt(6)
    v_mfma_f32_32x32x16_bf16 v[224:239], v[252:255], v[156:159], v[224:239]
    ds_read_b128 v[248:251], v9 offset:51200
    v_rcp_f32 v40, v40
    v_rcp_f32 v41, v41
    s_waitcnt lgkmcnt(6)
    v_mfma_f32_32x32x16_bf16 v[224:239], v[48:51], v[160:163], v[224:239]
    ds_read_b128 v[252:255], v9 offset:52224
    v_rcp_f32 v42, v42
    v_rcp_f32 v43, v43
    s_waitcnt lgkmcnt(6)
    v_mfma_f32_32x32x16_bf16 v[224:239], v[52:55], v[164:167], v[224:239]
    ds_read_b128 v[48:51], v9 offset:53248
    v_rcp_f32 v44, v44
    v_rcp_f32 v45, v45
    s_waitcnt lgkmcnt(6)
    v_mfma_f32_32x32x16_bf16 v[224:239], v[56:59], v[168:171], v[224:239]
    ds_read_b128 v[52:55], v9 offset:54272
    v_rcp_f32 v46, v46
    v_rcp_f32 v47, v47
    s_waitcnt lgkmcnt(6)
    v_mfma_f32_32x32x16_bf16 v[224:239], v[60:63], v[172:175], v[224:239]
    ds_read_b128 v[56:59], v9 offset:55296
    v_mul_f32 v208, v208, v40
    v_mul_f32 v209, v209, v41
    v_mul_f32 v210, v210, v42
    s_waitcnt lgkmcnt(6)
    v_mfma_f32_32x32x16_bf16 v[224:239], v[240:243], v[176:179], v[224:239]
    ds_read_b128 v[60:63], v9 offset:56320
    v_mul_f32 v211, v211, v43
    v_mul_f32 v212, v212, v44
    v_mul_f32 v213, v213, v45
    s_waitcnt lgkmcnt(6)
    v_mfma_f32_32x32x16_bf16 v[224:239], v[244:247], v[180:183], v[224:239]
    ds_read_b128 v[240:243], v8 offset:0
    v_mul_f32 v214, v214, v46
    v_mul_f32 v215, v215, v47
    v_cvt_pk_bf16_f32 v28, v208, v209
    s_waitcnt lgkmcnt(6)
    v_mfma_f32_32x32x16_bf16 v[224:239], v[248:251], v[184:187], v[224:239]
    ds_read_b128 v[244:247], v8 offset:1024
    v_cvt_pk_bf16_f32 v29, v210, v211
    v_cvt_pk_bf16_f32 v30, v212, v213
    v_cvt_pk_bf16_f32 v31, v214, v215
    s_waitcnt lgkmcnt(6)
    v_mfma_f32_32x32x16_bf16 v[224:239], v[252:255], v[188:191], v[224:239]
    ds_read_b128 v[248:251], v8 offset:2048
    s_waitcnt vmcnt(0)
    buffer_atomic_add v16, v17, s[52:55], s90 offen sc1
    s_add_u32 s13, s7, 270336
    buffer_store_dwordx4 v[28:31], v13, s[52:55], s13 offen sc1
    s_waitcnt lgkmcnt(6)
    v_mfma_f32_32x32x16_bf16 v[224:239], v[48:51], v[192:195], v[224:239]
    ds_read_b128 v[252:255], v8 offset:3072
    s_waitcnt lgkmcnt(6)
    v_mfma_f32_32x32x16_bf16 v[224:239], v[52:55], v[196:199], v[224:239]
    ds_read_b128 v[48:51], v8 offset:4096
    s_waitcnt lgkmcnt(6)
    v_mfma_f32_32x32x16_bf16 v[224:239], v[56:59], v[200:203], v[224:239]
    ds_read_b128 v[52:55], v8 offset:5120
    s_waitcnt lgkmcnt(6)
    v_mfma_f32_32x32x16_bf16 v[224:239], v[60:63], v[204:207], v[224:239]
    ds_read_b128 v[56:59], v8 offset:6144
    v_mfma_f32_32x32x16_bf16 v[224:239], v[68:71], v[32:35], v[224:239]
    ds_read_b128 v[64:67], v12 offset:6144
    s_waitcnt lgkmcnt(7)
    v_mfma_f32_32x32x16_bf16 v[208:223], v[240:243], v[96:99], 0
    ds_read_b128 v[60:63], v8 offset:7168
    s_waitcnt lgkmcnt(7)
    v_mfma_f32_32x32x16_bf16 v[208:223], v[244:247], v[100:103], v[208:223]
    ds_read_b128 v[240:243], v8 offset:8192
    s_waitcnt lgkmcnt(7)
    v_mfma_f32_32x32x16_bf16 v[208:223], v[248:251], v[104:107], v[208:223]
    ds_read_b128 v[244:247], v8 offset:9216
    s_nop 1
    v_mul_f32 v40, v14, v224
    v_mul_f32 v41, v14, v225
    v_mul_f32 v42, v14, v226
    s_waitcnt lgkmcnt(7)
    v_mfma_f32_32x32x16_bf16 v[208:223], v[252:255], v[108:111], v[208:223]
    ds_read_b128 v[248:251], v8 offset:10240
    v_mul_f32 v43, v14, v227
    v_mul_f32 v44, v14, v228
    v_mul_f32 v45, v14, v229
    s_waitcnt lgkmcnt(7)
    v_mfma_f32_32x32x16_bf16 v[208:223], v[48:51], v[112:115], v[208:223]
    ds_read_b128 v[252:255], v8 offset:11264
    v_mul_f32 v46, v14, v230
    v_mul_f32 v47, v14, v231
    v_exp_f32 v40, v40
    s_waitcnt lgkmcnt(7)
    v_mfma_f32_32x32x16_bf16 v[208:223], v[52:55], v[116:119], v[208:223]
    ds_read_b128 v[48:51], v8 offset:12288
    v_mul_f32 v224, v224, v232
    v_exp_f32 v41, v41
    s_waitcnt lgkmcnt(7)
    v_mfma_f32_32x32x16_bf16 v[208:223], v[56:59], v[120:123], v[208:223]
    ds_read_b128 v[52:55], v8 offset:13312
    v_mul_f32 v225, v225, v233
    v_exp_f32 v42, v42
    s_waitcnt lgkmcnt(6)
    v_mfma_f32_32x32x16_bf16 v[208:223], v[60:63], v[124:127], v[208:223]
    ds_read_b128 v[56:59], v8 offset:14336
    v_mul_f32 v226, v226, v234
    v_exp_f32 v43, v43
    s_waitcnt lgkmcnt(6)
    v_mfma_f32_32x32x16_bf16 v[208:223], v[240:243], v[128:131], v[208:223]
    ds_read_b128 v[60:63], v8 offset:15360
    v_mul_f32 v227, v227, v235
    v_exp_f32 v44, v44
    s_waitcnt lgkmcnt(6)
    v_mfma_f32_32x32x16_bf16 v[208:223], v[244:247], v[132:135], v[208:223]
    ds_read_b128 v[240:243], v8 offset:16384
    v_mul_f32 v228, v228, v236
    v_exp_f32 v45, v45
    s_waitcnt lgkmcnt(6)
    v_mfma_f32_32x32x16_bf16 v[208:223], v[248:251], v[136:139], v[208:223]
    ds_read_b128 v[244:247], v8 offset:17408
    v_mul_f32 v229, v229, v237
    v_exp_f32 v46, v46
    s_waitcnt lgkmcnt(6)
    v_mfma_f32_32x32x16_bf16 v[208:223], v[252:255], v[140:143], v[208:223]
    ds_read_b128 v[248:251], v8 offset:18432
    v_mul_f32 v230, v230, v238
    v_exp_f32 v47, v47
    s_waitcnt lgkmcnt(6)
    v_mfma_f32_32x32x16_bf16 v[208:223], v[48:51], v[144:147], v[208:223]
    ds_read_b128 v[252:255], v8 offset:19456
    v_mul_f32 v231, v231, v239
    v_fma_f32 v40, v40, v27, v27
    v_fma_f32 v41, v41, v27, v27
    s_waitcnt lgkmcnt(6)
    v_mfma_f32_32x32x16_bf16 v[208:223], v[52:55], v[148:151], v[208:223]
    ds_read_b128 v[48:51], v8 offset:20480
    v_fma_f32 v42, v42, v27, v27
    v_fma_f32 v43, v43, v27, v27
    v_fma_f32 v44, v44, v27, v27
    s_waitcnt lgkmcnt(6)
    v_mfma_f32_32x32x16_bf16 v[208:223], v[56:59], v[152:155], v[208:223]
    ds_read_b128 v[52:55], v8 offset:21504
    v_fma_f32 v45, v45, v27, v27
    v_fma_f32 v46, v46, v27, v27
    v_fma_f32 v47, v47, v27, v27
    s_waitcnt lgkmcnt(6)
    v_mfma_f32_32x32x16_bf16 v[208:223], v[60:63], v[156:159], v[208:223]
    ds_read_b128 v[56:59], v8 offset:22528
    v_rcp_f32 v40, v40
    v_rcp_f32 v41, v41
    s_waitcnt lgkmcnt(6)
    v_mfma_f32_32x32x16_bf16 v[208:223], v[240:243], v[160:163], v[208:223]
    ds_read_b128 v[60:63], v8 offset:23552
    v_rcp_f32 v42, v42
    v_rcp_f32 v43, v43
    s_waitcnt lgkmcnt(6)
    v_mfma_f32_32x32x16_bf16 v[208:223], v[244:247], v[164:167], v[208:223]
    ds_read_b128 v[240:243], v8 offset:24576
    v_rcp_f32 v44, v44
    v_rcp_f32 v45, v45
    s_waitcnt lgkmcnt(6)
    v_mfma_f32_32x32x16_bf16 v[208:223], v[248:251], v[168:171], v[208:223]
    ds_read_b128 v[244:247], v8 offset:25600
    v_rcp_f32 v46, v46
    v_rcp_f32 v47, v47
    s_waitcnt lgkmcnt(6)
    v_mfma_f32_32x32x16_bf16 v[208:223], v[252:255], v[172:175], v[208:223]
    ds_read_b128 v[248:251], v8 offset:26624
    v_mul_f32 v224, v224, v40
    v_mul_f32 v225, v225, v41
    v_mul_f32 v226, v226, v42
    s_waitcnt lgkmcnt(6)
    v_mfma_f32_32x32x16_bf16 v[208:223], v[48:51], v[176:179], v[208:223]
    ds_read_b128 v[252:255], v8 offset:27648
    v_mul_f32 v227, v227, v43
    v_mul_f32 v228, v228, v44
    v_mul_f32 v229, v229, v45
    s_waitcnt lgkmcnt(6)
    v_mfma_f32_32x32x16_bf16 v[208:223], v[52:55], v[180:183], v[208:223]
    v_mul_f32 v230, v230, v46
    v_mul_f32 v231, v231, v47
    v_cvt_pk_bf16_f32 v28, v224, v225
    s_waitcnt lgkmcnt(5)
    v_mfma_f32_32x32x16_bf16 v[208:223], v[56:59], v[184:187], v[208:223]
    v_cvt_pk_bf16_f32 v29, v226, v227
    v_cvt_pk_bf16_f32 v30, v228, v229
    v_cvt_pk_bf16_f32 v31, v230, v231
    s_waitcnt lgkmcnt(4)
    v_mfma_f32_32x32x16_bf16 v[208:223], v[60:63], v[188:191], v[208:223]
    s_add_u32 s13, s7, 337920
    buffer_store_dwordx4 v[28:31], v13, s[52:55], s13 offen sc1
    s_waitcnt lgkmcnt(3)
    v_mfma_f32_32x32x16_bf16 v[208:223], v[240:243], v[192:195], v[208:223]
    s_waitcnt lgkmcnt(2)
    v_mfma_f32_32x32x16_bf16 v[208:223], v[244:247], v[196:199], v[208:223]
    s_waitcnt lgkmcnt(1)
    v_mfma_f32_32x32x16_bf16 v[208:223], v[248:251], v[200:203], v[208:223]
    s_waitcnt lgkmcnt(0)
    v_mfma_f32_32x32x16_bf16 v[208:223], v[252:255], v[204:207], v[208:223]
    v_mfma_f32_32x32x16_bf16 v[208:223], v[64:67], v[32:35], v[208:223]
    s_nop 11
    v_mul_f32 v40, v14, v208
    v_mul_f32 v41, v14, v209
    v_mul_f32 v42, v14, v210
    v_mul_f32 v43, v14, v211
    v_mul_f32 v44, v14, v212
    v_mul_f32 v45, v14, v213
    v_mul_f32 v46, v14, v214
    v_mul_f32 v47, v14, v215
    v_exp_f32 v40, v40
    v_mul_f32 v208, v208, v216
    v_exp_f32 v41, v41
    v_mul_f32 v209, v209, v217
    v_exp_f32 v42, v42
    v_mul_f32 v210, v210, v218
    v_exp_f32 v43, v43
    v_mul_f32 v211, v211, v219
    v_exp_f32 v44, v44
    v_mul_f32 v212, v212, v220
    v_exp_f32 v45, v45
    v_mul_f32 v213, v213, v221
    v_exp_f32 v46, v46
    v_mul_f32 v214, v214, v222
    v_exp_f32 v47, v47
    v_mul_f32 v215, v215, v223
    v_fma_f32 v40, v40, v27, v27
    v_fma_f32 v41, v41, v27, v27
    v_fma_f32 v42, v42, v27, v27
    v_fma_f32 v43, v43, v27, v27
    v_fma_f32 v44, v44, v27, v27
    v_fma_f32 v45, v45, v27, v27
    v_fma_f32 v46, v46, v27, v27
    v_fma_f32 v47, v47, v27, v27
    v_rcp_f32 v40, v40
    v_rcp_f32 v41, v41
    v_rcp_f32 v42, v42
    v_rcp_f32 v43, v43
    v_rcp_f32 v44, v44
    v_rcp_f32 v45, v45
    v_rcp_f32 v46, v46
    v_rcp_f32 v47, v47
    v_mul_f32 v208, v208, v40
    v_mul_f32 v209, v209, v41
    v_mul_f32 v210, v210, v42
    v_mul_f32 v211, v211, v43
    v_mul_f32 v212, v212, v44
    v_mul_f32 v213, v213, v45
    v_mul_f32 v214, v214, v46
    v_mul_f32 v215, v215, v47
    v_cvt_pk_bf16_f32 v28, v208, v209
    v_cvt_pk_bf16_f32 v29, v210, v211
    v_cvt_pk_bf16_f32 v30, v212, v213
    v_cvt_pk_bf16_f32 v31, v214, v215
    s_add_u32 s13, s7, 405504
    buffer_store_dwordx4 v[28:31], v13, s[52:55], s13 offen sc1
    s_waitcnt vmcnt(0)
    v_mov_b32 v20, 162824
    v_cmp_eq_u32 vcc, 0, v1
    s_nop 1
    s_and_saveexec_b64 s[10:11], vcc
    ds_add_rtn_u32 v20, v20, v16
    s_waitcnt lgkmcnt(0)
    v_readfirstlane_b32 s12, v20
    s_mov_b64 exec, s[10:11]
    s_nop 0
    s_cmp_lg_u32 s12, 3
    s_cbranch_scc1 L_k4_nosig
    buffer_atomic_add v16, v17, s[52:55], s91 offen sc1
L_k4_nosig:
L_k4_exit:
    s_endpgm
L_k4_load:
    s_sub_u32 s4, s4, 4
    v_subrev_u32 v3, 256, v0
    v_lshlrev_b32 v8, 4, v1
    v_lshrrev_b32 v6, 4, v1
    v_mul_u32_u24 v9, 4352, v6
    v_bfe_u32 v7, v1, 2, 2
    v_xor_b32 v6, v6, v7
    v_lshl_add_u32 v9, v6, 6, v9
    v_and_b32 v6, 3, v1
    v_lshl_add_u32 v9, v6, 4, v9
    s_lshl_b32 s7, s3, 8
    s_mul_i32 s8, s4, 69632
    s_add_u32 s7, s7, s8
    s_add_u32 s7, s7, 4194304
    s_lshl_b32 s10, s4, 10
    s_mul_i32 s12, s5, 200704
    s_add_u32 s12, s12, s10
    s_add_u32 s12, s12, 16777216
    s_lshl_b32 s11, s4, 12
    v_cmp_le_u32 vcc, 112, v3
    v_mov_b32 v6, 0
    v_mov_b32 v7, 6720
    v_cndmask_b32 v6, v6, v7, vcc
    v_lshl_add_u32 v10, v3, 2, v6
    v_mov_b32 v6, 0
    v_mov_b32 v7, -6912
    v_cndmask_b32 v11, v6, v7, vcc
    v_lshrrev_b32 v6, 4, v3
    v_lshl_add_u32 v11, v6, 10, v11
    v_and_b32 v6, 3, v3
    v_lshl_add_u32 v11, v6, 4, v11
    v_bfe_u32 v6, v3, 2, 1
    v_lshl_add_u32 v11, v6, 7, v11
    v_bfe_u32 v6, v3, 3, 1
    v_lshl_add_u32 v11, v6, 6, v11
    v_add_u32 v11, 155648, v11
    s_mul_i32 s13, s5, 448
    s_add_u32 s13, s13, 6422528
    v_cmp_gt_u32 vcc, 224, v3
    s_nop 1
    s_mov_b64 s[60:61], vcc
    s_lshr_b32 s58, s2, 3
    s_mul_hi_u32 s56, s58, 613566757
    s_mul_i32 s57, s56, 7
    s_sub_u32 s57, s58, s57
    s_and_b32 s58, s2, 7
    s_lshl_b32 s58, s58, 2
    s_add_u32 s56, s56, s58
    s_mul_i32 s62, s57, 229376
    s_mul_i32 s58, s4, 57344
    s_add_u32 s62, s62, s58
    s_add_u32 s62, s62, 20971520
    s_lshr_b32 s58, s4, 1
    s_lshl_b32 s58, s58, 10
    s_add_u32 s63, s62, 1024
    s_sub_u32 s63, s63, s58
    s_add_u32 s62, s62, s58
    s_waitcnt lgkmcnt(0)
    s_mov_b32 s52, s44
    s_mov_b32 s53, s45
    s_mov_b32 s54, 22577152
    s_mov_b32 s55, 131072
    v_mov_b32 v64, 162816
    v_mov_b32 v66, 0
    v_mov_b32 v67, 0
    v_mov_b32 v68, 0
    v_mov_b32 v69, 0
    ds_write_b128 v64, v[66:69]
    s_add_u32 m0, s11, 0
    s_add_u32 s15, s7, 0
    buffer_load_dwordx4 v9, s[52:55], s15 offen lds
    s_add_u32 m0, s11, 1024
    s_add_u32 s15, s7, 17408
    buffer_load_dwordx4 v9, s[52:55], s15 offen lds
    s_add_u32 m0, s11, 2048
    s_add_u32 s15, s7, 34816
    buffer_load_dwordx4 v9, s[52:55], s15 offen lds
    s_add_u32 m0, s11, 3072
    s_add_u32 s15, s7, 52224
    buffer_load_dwordx4 v9, s[52:55], s15 offen lds
    s_add_u32 m0, s10, 126976
    s_add_u32 s15, s12, 0
    buffer_load_dwordx4 v8, s[52:55], s15 offen lds
    s_add_u32 m0, s11, 16384
    s_add_u32 s15, s7, 278528
    buffer_load_dwordx4 v9, s[52:55], s15 offen lds
    s_add_u32 m0, s11, 17408
    s_add_u32 s15, s7, 295936
    buffer_load_dwordx4 v9, s[52:55], s15 offen lds
    s_add_u32 m0, s11, 18432
    s_add_u32 s15, s7, 313344
    buffer_load_dwordx4 v9, s[52:55], s15 offen lds
    s_add_u32 m0, s11, 19456
    s_add_u32 s15, s7, 330752
    buffer_load_dwordx4 v9, s[52:55], s15 offen lds
    s_add_u32 m0, s10, 131072
    s_add_u32 s15, s12, 4096
    buffer_load_dwordx4 v8, s[52:55], s15 offen lds
    s_add_u32 m0, s11, 32768
    s_add_u32 s15, s7, 557056
    buffer_load_dwordx4 v9, s[52:55], s15 offen lds
    s_add_u32 m0, s11, 33792
    s_add_u32 s15, s7, 574464
    buffer_load_dwordx4 v9, s[52:55], s15 offen lds
    s_add_u32 m0, s11, 34816
    s_add_u32 s15, s7, 591872
    buffer_load_dwordx4 v9, s[52:55], s15 offen lds
    s_add_u32 m0, s11, 35840
    s_add_u32 s15, s7, 609280
    buffer_load_dwordx4 v9, s[52:55], s15 offen lds
    s_add_u32 m0, s10, 135168
    s_add_u32 s15, s12, 8192
    buffer_load_dwordx4 v8, s[52:55], s15 offen lds
    s_waitcnt lgkmcnt(0)
    s_waitcnt vmcnt(10)
    s_barrier
    s_add_u32 m0, s11, 49152
    s_add_u32 s15, s7, 835584
    buffer_load_dwordx4 v9, s[52:55], s15 offen lds
    s_add_u32 m0, s11, 50176
    s_add_u32 s15, s7, 852992
    buffer_load_dwordx4 v9, s[52:55], s15 offen lds
    s_add_u32 m0, s11, 51200
    s_add_u32 s15, s7, 870400
    buffer_load_dwordx4 v9, s[52:55], s15 offen lds
    s_add_u32 m0, s11, 52224
    s_add_u32 s15, s7, 887808
    buffer_load_dwordx4 v9, s[52:55], s15 offen lds
    s_add_u32 m0, s10, 139264
    s_add_u32 s15, s12, 12288
    buffer_load_dwordx4 v8, s[52:55], s15 offen lds
    s_waitcnt vmcnt(10)
    s_barrier
    s_add_u32 m0, s11, 65536
    s_add_u32 s15, s7, 1114112
    buffer_load_dwordx4 v9, s[52:55], s15 offen lds
    s_add_u32 m0, s11, 66560
    s_add_u32 s15, s7, 1131520
    buffer_load_dwordx4 v9, s[52:55], s15 offen lds
    s_add_u32 m0, s11, 67584
    s_add_u32 s15, s7, 1148928
    buffer_load_dwordx4 v9, s[52:55], s15 offen lds
    s_add_u32 m0, s11, 68608
    s_add_u32 s15, s7, 1166336
    buffer_load_dwordx4 v9, s[52:55], s15 offen lds
    s_add_u32 m0, s10, 143360
    s_add_u32 s15, s12, 16384
    buffer_load_dwordx4 v8, s[52:55], s15 offen lds
    s_waitcnt vmcnt(10)
    s_barrier
    s_add_u32 m0, s11, 81920
    s_add_u32 s15, s7, 1392640
    buffer_load_dwordx4 v9, s[52:55], s15 offen lds
    s_add_u32 m0, s11, 82944
    s_add_u32 s15, s7, 1410048
    buffer_load_dwordx4 v9, s[52:55], s15 offen lds
    s_add_u32 m0, s11, 83968
    s_add_u32 s15, s7, 1427456
    buffer_load_dwordx4 v9, s[52:55], s15 offen lds
    s_add_u32 m0, s11, 84992
    s_add_u32 s15, s7, 1444864
    buffer_load_dwordx4 v9, s[52:55], s15 offen lds
    s_add_u32 m0, s10, 147456
    s_add_u32 s15, s12, 20480
    buffer_load_dwordx4 v8, s[52:55], s15 offen lds
    s_waitcnt vmcnt(10)
    s_barrier
    s_add_u32 m0, s11, 98304
    s_add_u32 s15, s7, 1671168
    buffer_load_dwordx4 v9, s[52:55], s15 offen lds
    s_add_u32 m0, s11, 99328
    s_add_u32 s15, s7, 1688576
    buffer_load_dwordx4 v9, s[52:55], s15 offen lds
    s_add_u32 m0, s11, 100352
    s_add_u32 s15, s7, 1705984
    buffer_load_dwordx4 v9, s[52:55], s15 offen lds
    s_add_u32 m0, s11, 101376
    s_add_u32 s15, s7, 1723392
    buffer_load_dwordx4 v9, s[52:55], s15 offen lds
    s_add_u32 m0, s10, 151552
    s_add_u32 s15, s12, 24576
    buffer_load_dwordx4 v8, s[52:55], s15 offen lds
    s_mov_b64 s[68:69], exec
    s_mov_b64 exec, s[60:61]
    s_add_u32 s15, s13, 0
    buffer_load_dword v48, v10, s[52:55], s15 offen
    s_add_u32 s15, s13, 14336
    buffer_load_dword v49, v10, s[52:55], s15 offen
    s_add_u32 s15, s13, 28672
    buffer_load_dword v50, v10, s[52:55], s15 offen
    s_add_u32 s15, s13, 43008
    buffer_load_dword v51, v10, s[52:55], s15 offen
    s_add_u32 s15, s13, 57344
    buffer_load_dword v52, v10, s[52:55], s15 offen
    s_add_u32 s15, s13, 71680
    buffer_load_dword v53, v10, s[52:55], s15 offen
    s_add_u32 s15, s13, 86016
    buffer_load_dword v54, v10, s[52:55], s15 offen
    s_add_u32 s15, s13, 100352
    buffer_load_dword v55, v10, s[52:55], s15 offen
    s_add_u32 s15, s13, 131072
    buffer_load_dword v56, v10, s[52:55], s15 offen
    s_add_u32 s15, s13, 145408
    buffer_load_dword v57, v10, s[52:55], s15 offen
    s_add_u32 s15, s13, 159744
    buffer_load_dword v58, v10, s[52:55], s15 offen
    s_add_u32 s15, s13, 174080
    buffer_load_dword v59, v10, s[52:55], s15 offen
    s_add_u32 s15, s13, 188416
    buffer_load_dword v60, v10, s[52:55], s15 offen
    s_add_u32 s15, s13, 202752
    buffer_load_dword v61, v10, s[52:55], s15 offen
    s_add_u32 s15, s13, 217088
    buffer_load_dword v62, v10, s[52:55], s15 offen
    s_add_u32 s15, s13, 231424
    buffer_load_dword v63, v10, s[52:55], s15 offen
    s_mov_b64 exec, s[68:69]
    s_waitcnt vmcnt(26)
    s_barrier
    s_add_u32 m0, s10, 0
    s_add_u32 s15, s12, 28672
    buffer_load_dwordx4 v8, s[52:55], s15 offen lds
    s_add_u32 m0, s10, 4096
    s_add_u32 s15, s12, 32768
    buffer_load_dwordx4 v8, s[52:55], s15 offen lds
    s_add_u32 m0, s10, 8192
    s_add_u32 s15, s12, 36864
    buffer_load_dwordx4 v8, s[52:55], s15 offen lds
    s_add_u32 m0, s10, 12288
    s_add_u32 s15, s12, 40960
    buffer_load_dwordx4 v8, s[52:55], s15 offen lds
    s_add_u32 m0, s10, 16384
    s_add_u32 s15, s12, 45056
    buffer_load_dwordx4 v8, s[52:55], s15 offen lds
    s_add_u32 m0, s10, 20480
    s_add_u32 s15, s12, 49152
    buffer_load_dwordx4 v8, s[52:55], s15 offen lds
    s_add_u32 m0, s10, 24576
    s_add_u32 s15, s12, 53248
    buffer_load_dwordx4 v8, s[52:55], s15 offen lds
    s_waitcnt vmcnt(28)
    s_barrier
    s_add_u32 m0, s10, 32768
    s_add_u32 s15, s12, 57344
    buffer_load_dwordx4 v8, s[52:55], s15 offen lds
    s_add_u32 m0, s10, 36864
    s_add_u32 s15, s12, 61440
    buffer_load_dwordx4 v8, s[52:55], s15 offen lds
    s_add_u32 m0, s10, 40960
    s_add_u32 s15, s12, 65536
    buffer_load_dwordx4 v8, s[52:55], s15 offen lds
    s_add_u32 m0, s10, 45056
    s_add_u32 s15, s12, 69632
    buffer_load_dwordx4 v8, s[52:55], s15 offen lds
    s_add_u32 m0, s10, 49152
    s_add_u32 s15, s12, 73728
    buffer_load_dwordx4 v8, s[52:55], s15 offen lds
    s_add_u32 m0, s10, 53248
    s_add_u32 s15, s12, 77824
    buffer_load_dwordx4 v8, s[52:55], s15 offen lds
    s_add_u32 m0, s10, 57344
    s_add_u32 s15, s12, 81920
    buffer_load_dwordx4 v8, s[52:55], s15 offen lds
    s_waitcnt vmcnt(14)
    v_add_f32 v48, v48, v49
    v_add_f32 v50, v50, v51
    v_add_f32 v52, v52, v53
    v_add_f32 v54, v54, v55
    v_add_f32 v56, v56, v57
    v_add_f32 v58, v58, v59
    v_add_f32 v60, v60, v61
    v_add_f32 v62, v62, v63
    v_add_f32 v48, v48, v50
    v_add_f32 v52, v52, v54
    v_add_f32 v56, v56, v58
    v_add_f32 v60, v60, v62
    v_add_f32 v48, v48, v52
    v_add_f32 v56, v56, v60
    v_cvt_pk_bf16_f32 v49, v56, v48
    v_lshlrev_b32 v50, 16, v49
    v_and_b32 v51, s6, v49
    v_sub_f32 v56, v56, v50
    v_sub_f32 v48, v48, v51
    v_cvt_pk_bf16_f32 v64, v50, v56
    v_cvt_pk_bf16_f32 v65, v51, v48
    v_mov_b32 v66, 0
    v_mov_b32 v67, 0
    v_mov_b32 v68, 0
    v_mov_b32 v69, 0
    v_mov_b32 v70, 0
    v_mov_b32 v71, 0
    s_mov_b64 exec, s[60:61]
    ds_write_b128 v11, v[64:67]
    ds_write_b128 v11, v[68:71] offset:512
    s_mov_b64 exec, s[68:69]
    s_waitcnt lgkmcnt(0)
    s_barrier
    s_add_u32 m0, s10, 65536
    s_add_u32 s15, s12, 86016
    buffer_load_dwordx4 v8, s[52:55], s15 offen lds
    s_add_u32 m0, s10, 69632
    s_add_u32 s15, s12, 90112
    buffer_load_dwordx4 v8, s[52:55], s15 offen lds
    s_add_u32 m0, s10, 73728
    s_add_u32 s15, s12, 94208
    buffer_load_dwordx4 v8, s[52:55], s15 offen lds
    s_add_u32 m0, s10, 77824
    s_add_u32 s15, s12, 98304
    buffer_load_dwordx4 v8, s[52:55], s15 offen lds
    s_add_u32 m0, s10, 81920
    s_add_u32 s15, s12, 102400
    buffer_load_dwordx4 v8, s[52:55], s15 offen lds
    s_add_u32 m0, s10, 86016
    s_add_u32 s15, s12, 106496
    buffer_load_dwordx4 v8, s[52:55], s15 offen lds
    s_add_u32 m0, s10, 90112
    s_add_u32 s15, s12, 110592
    buffer_load_dwordx4 v8, s[52:55], s15 offen lds
    s_waitcnt vmcnt(14)
    s_barrier
    s_add_u32 m0, s10, 98304
    s_add_u32 s15, s12, 114688
    buffer_load_dwordx4 v8, s[52:55], s15 offen lds
    s_add_u32 m0, s10, 102400
    s_add_u32 s15, s12, 118784
    buffer_load_dwordx4 v8, s[52:55], s15 offen lds
    s_add_u32 m0, s10, 106496
    s_add_u32 s15, s12, 122880
    buffer_load_dwordx4 v8, s[52:55], s15 offen lds
    s_add_u32 m0, s10, 110592
    s_add_u32 s15, s12, 126976
    buffer_load_dwordx4 v8, s[52:55], s15 offen lds
    s_add_u32 m0, s10, 114688
    s_add_u32 s15, s12, 131072
    buffer_load_dwordx4 v8, s[52:55], s15 offen lds
    s_add_u32 m0, s10, 118784
    s_add_u32 s15, s12, 135168
    buffer_load_dwordx4 v8, s[52:55], s15 offen lds
    s_add_u32 m0, s10, 122880
    s_add_u32 s15, s12, 139264
    buffer_load_dwordx4 v8, s[52:55], s15 offen lds
    s_add_u32 s15, s62, 0
    s_add_u32 s14, s63, 0
    buffer_load_dwordx4 v[16:19], v8, s[52:55], s15 offen
    buffer_load_dwordx4 v[20:23], v8, s[52:55], s14 offen
    s_add_u32 s15, s62, 14336
    s_add_u32 s14, s63, 14336
    buffer_load_dwordx4 v[24:27], v8, s[52:55], s15 offen
    buffer_load_dwordx4 v[28:31], v8, s[52:55], s14 offen
    s_add_u32 s15, s62, 28672
    s_add_u32 s14, s63, 28672
    buffer_load_dwordx4 v[32:35], v8, s[52:55], s15 offen
    buffer_load_dwordx4 v[36:39], v8, s[52:55], s14 offen
    s_add_u32 s15, s62, 43008
    s_add_u32 s14, s63, 43008
    buffer_load_dwordx4 v[40:43], v8, s[52:55], s15 offen
    buffer_load_dwordx4 v[44:47], v8, s[52:55], s14 offen
    s_add_u32 s15, s62, 2048
    s_add_u32 s14, s63, 2048
    buffer_load_dwordx4 v[48:51], v8, s[52:55], s15 offen
    buffer_load_dwordx4 v[52:55], v8, s[52:55], s14 offen
    s_add_u32 s15, s62, 16384
    s_add_u32 s14, s63, 16384
    buffer_load_dwordx4 v[56:59], v8, s[52:55], s15 offen
    buffer_load_dwordx4 v[60:63], v8, s[52:55], s14 offen
    s_waitcnt vmcnt(19)
    s_barrier
    s_add_u32 m0, s10, 126976
    s_add_u32 s15, s12, 143360
    buffer_load_dwordx4 v8, s[52:55], s15 offen lds
    s_add_u32 m0, s10, 131072
    s_add_u32 s15, s12, 147456
    buffer_load_dwordx4 v8, s[52:55], s15 offen lds
    s_add_u32 m0, s10, 135168
    s_add_u32 s15, s12, 151552
    buffer_load_dwordx4 v8, s[52:55], s15 offen lds
    s_add_u32 m0, s10, 139264
    s_add_u32 s15, s12, 155648
    buffer_load_dwordx4 v8, s[52:55], s15 offen lds
    s_add_u32 m0, s10, 143360
    s_add_u32 s15, s12, 159744
    buffer_load_dwordx4 v8, s[52:55], s15 offen lds
    s_add_u32 m0, s10, 147456
    s_add_u32 s15, s12, 163840
    buffer_load_dwordx4 v8, s[52:55], s15 offen lds
    s_add_u32 m0, s10, 151552
    s_add_u32 s15, s12, 167936
    buffer_load_dwordx4 v8, s[52:55], s15 offen lds
    s_add_u32 m0, s10, 0
    s_add_u32 s15, s12, 172032
    buffer_load_dwordx4 v8, s[52:55], s15 offen lds
    s_add_u32 m0, s10, 4096
    s_add_u32 s15, s12, 176128
    buffer_load_dwordx4 v8, s[52:55], s15 offen lds
    s_add_u32 m0, s10, 8192
    s_add_u32 s15, s12, 180224
    buffer_load_dwordx4 v8, s[52:55], s15 offen lds
    s_add_u32 m0, s10, 12288
    s_add_u32 s15, s12, 184320
    buffer_load_dwordx4 v8, s[52:55], s15 offen lds
    s_add_u32 m0, s10, 16384
    s_add_u32 s15, s12, 188416
    buffer_load_dwordx4 v8, s[52:55], s15 offen lds
    s_add_u32 m0, s10, 20480
    s_add_u32 s15, s12, 192512
    buffer_load_dwordx4 v8, s[52:55], s15 offen lds
    s_add_u32 m0, s10, 24576
    s_add_u32 s15, s12, 196608
    buffer_load_dwordx4 v8, s[52:55], s15 offen lds
    s_waitcnt vmcnt(0)
    s_barrier
    s_add_u32 s15, s62, 30720
    s_add_u32 s14, s63, 30720
    buffer_load_dwordx4 v[64:67], v8, s[52:55], s15 offen
    buffer_load_dwordx4 v[68:71], v8, s[52:55], s14 offen
    s_add_u32 s15, s62, 45056
    s_add_u32 s14, s63, 45056
    buffer_load_dwordx4 v[72:75], v8, s[52:55], s15 offen
    buffer_load_dwordx4 v[76:79], v8, s[52:55], s14 offen
    s_add_u32 s15, s62, 4096
    s_add_u32 s14, s63, 4096
    buffer_load_dwordx4 v[80:83], v8, s[52:55], s15 offen
    buffer_load_dwordx4 v[84:87], v8, s[52:55], s14 offen
    s_add_u32 s15, s62, 18432
    s_add_u32 s14, s63, 18432
    buffer_load_dwordx4 v[88:91], v8, s[52:55], s15 offen
    buffer_load_dwordx4 v[92:95], v8, s[52:55], s14 offen
    s_add_u32 s15, s62, 32768
    s_add_u32 s14, s63, 32768
    buffer_load_dwordx4 v[96:99], v8, s[52:55], s15 offen
    buffer_load_dwordx4 v[100:103], v8, s[52:55], s14 offen
    s_add_u32 s15, s62, 47104
    s_add_u32 s14, s63, 47104
    buffer_load_dwordx4 v[104:107], v8, s[52:55], s15 offen
    buffer_load_dwordx4 v[108:111], v8, s[52:55], s14 offen
    s_add_u32 s15, s62, 6144
    s_add_u32 s14, s63, 6144
    buffer_load_dwordx4 v[112:115], v8, s[52:55], s15 offen
    buffer_load_dwordx4 v[116:119], v8, s[52:55], s14 offen
    s_add_u32 s15, s62, 20480
    s_add_u32 s14, s63, 20480
    buffer_load_dwordx4 v[120:123], v8, s[52:55], s15 offen
    buffer_load_dwordx4 v[124:127], v8, s[52:55], s14 offen
    s_add_u32 s15, s62, 34816
    s_add_u32 s14, s63, 34816
    buffer_load_dwordx4 v[128:131], v8, s[52:55], s15 offen
    buffer_load_dwordx4 v[132:135], v8, s[52:55], s14 offen
    s_add_u32 s15, s62, 49152
    s_add_u32 s14, s63, 49152
    buffer_load_dwordx4 v[136:139], v8, s[52:55], s15 offen
    buffer_load_dwordx4 v[140:143], v8, s[52:55], s14 offen
    s_lshl_b32 s58, s4, 14
    s_add_u32 s58, s58, 32768
    s_add_u32 m0, s58, 0
    s_add_u32 s15, s62, 8192
    buffer_load_dwordx4 v8, s[52:55], s15 offen lds
    s_add_u32 m0, s58, 1024
    s_add_u32 s15, s63, 8192
    buffer_load_dwordx4 v8, s[52:55], s15 offen lds
    s_add_u32 m0, s58, 2048
    s_add_u32 s15, s62, 22528
    buffer_load_dwordx4 v8, s[52:55], s15 offen lds
    s_add_u32 m0, s58, 3072
    s_add_u32 s15, s63, 22528
    buffer_load_dwordx4 v8, s[52:55], s15 offen lds
    s_add_u32 m0, s58, 4096
    s_add_u32 s15, s62, 36864
    buffer_load_dwordx4 v8, s[52:55], s15 offen lds
    s_add_u32 m0, s58, 5120
    s_add_u32 s15, s63, 36864
    buffer_load_dwordx4 v8, s[52:55], s15 offen lds
    s_add_u32 m0, s58, 6144
    s_add_u32 s15, s62, 51200
    buffer_load_dwordx4 v8, s[52:55], s15 offen lds
    s_add_u32 m0, s58, 7168
    s_add_u32 s15, s63, 51200
    buffer_load_dwordx4 v8, s[52:55], s15 offen lds
    s_add_u32 m0, s58, 8192
    s_add_u32 s15, s62, 10240
    buffer_load_dwordx4 v8, s[52:55], s15 offen lds
    s_add_u32 m0, s58, 9216
    s_add_u32 s15, s63, 10240
    buffer_load_dwordx4 v8, s[52:55], s15 offen lds
    s_add_u32 m0, s58, 10240
    s_add_u32 s15, s62, 24576
    buffer_load_dwordx4 v8, s[52:55], s15 offen lds
    s_add_u32 m0, s58, 11264
    s_add_u32 s15, s63, 24576
    buffer_load_dwordx4 v8, s[52:55], s15 offen lds
    s_add_u32 m0, s58, 12288
    s_add_u32 s15, s62, 38912
    buffer_load_dwordx4 v8, s[52:55], s15 offen lds
    s_add_u32 m0, s58, 13312
    s_add_u32 s15, s63, 38912
    buffer_load_dwordx4 v8, s[52:55], s15 offen lds
    s_add_u32 m0, s58, 14336
    s_add_u32 s15, s62, 53248
    buffer_load_dwordx4 v8, s[52:55], s15 offen lds
    s_add_u32 m0, s58, 15360
    s_add_u32 s15, s63, 53248
    buffer_load_dwordx4 v8, s[52:55], s15 offen lds
    v_lshrrev_b32 v4, 5, v1
    v_and_b32 v6, 31, v1
    v_lshlrev_b32 v5, 4, v6
    v_mul_u32_u24 v7, 33792, v4
    v_add_u32 v5, v5, v7
    s_and_b32 s58, s4, 1
    s_lshl_b32 s58, s58, 9
    v_add_u32 v9, 512, v5
    v_subrev_u32 v9, s58, v9
    v_add_u32 v5, s58, v5
    s_mul_i32 s7, s4, 1892352
    s_lshl_b32 s8, s56, 10
    s_add_u32 s7, s7, s8
    s_add_u32 s7, s7, 8388608
    v_mul_u32_u24 v15, 896, v6
    v_lshl_add_u32 v15, v4, 4, v15
    s_and_b32 s58, s4, 1
    s_mul_i32 s64, s58, 28672
    s_mul_i32 s59, s56, 57344
    s_add_u32 s64, s64, s59
    s_lshl_b32 s59, s57, 7
    s_add_u32 s64, s64, s59
    s_lshr_b32 s59, s4, 1
    s_lshl_b32 s59, s59, 6
    s_add_u32 s64, s64, s59
    v_lshlrev_b32 v11, 5, v4
    s_lshl_b32 s65, s57, 8
    s_lshl_b32 s59, s59, 1
    s_add_u32 s65, s65, s59
    s_add_u32 s65, s65, 6365952
    v_lshrrev_b32 v6, 2, v1
    v_mul_u32_u24 v10, 4352, v6
    v_and_b32 v6, 3, v1
    v_lshl_add_u32 v10, v6, 4, v10
    s_mul_i32 s9, s57, 278528
    s_lshr_b32 s10, s4, 1
    s_mul_i32 s10, s10, 139264
    s_add_u32 s9, s9, s10
    s_lshl_b32 s10, s56, 7
    s_add_u32 s9, s9, s10
    s_and_b32 s10, s4, 1
    s_lshl_b32 s10, s10, 6
    s_add_u32 s9, s9, s10
    s_add_u32 s9, s9, 4194304
    s_lshl_b32 s10, s4, 11
    v_bfe_u32 v6, v1, 2, 2
    v_lshl_add_u32 v6, v4, 3, v6
    v_lshlrev_b32 v3, 6, v6
    v_bfe_u32 v6, v1, 4, 1
    v_lshl_add_u32 v3, v6, 5, v3
    v_and_b32 v6, 3, v1
    v_lshl_add_u32 v3, v6, 3, v3
    v_add_u32 v3, s10, v3
    s_lshl_b32 s58, s4, 14
    s_add_u32 s58, s58, 32768
    v_add_u32 v12, s58, v8
    s_mul_i32 s58, s4, 12288
    s_add_u32 s58, s58, 98304
    v_add_u32 v2, s58, v8
    v_mov_b32 v13, 0
    s_mov_b32 s68, s40
    s_mov_b32 s69, s41
    s_mov_b32 s70, 1835008
    s_mov_b32 s71, 131072
    s_lshr_b32 s66, s56, 1
    s_lshl_b32 s66, s66, 8
    s_add_u32 s66, s66, 6815744
    s_cmp_ge_u32 s2, 224
    s_cbranch_scc1 L_k4_exit
    v_mov_b32 v6, 162816
    s_cmp_lg_u32 s4, 0
    s_cbranch_scc1 L_k4_lw1
    s_mov_b32 s67, 0
L_k4_poll1:
    buffer_load_dword v14, v13, s[52:55], s66 offen offset:0 sc1
    s_waitcnt vmcnt(0)
    v_readfirstlane_b32 s58, v14
    s_add_u32 s67, s67, 1
    s_nop 0
    s_cmp_ge_u32 s58, 64
    s_cbranch_scc1 L_k4_set1
    s_sleep 2
    s_cmp_lt_u32 s67, 262144
    s_cbranch_scc1 L_k4_poll1
L_k4_set1:
    v_mov_b32 v14, 1
    ds_write_b32 v6, v14 offset:0
    s_branch L_k4_go1
L_k4_lw1:
    ds_read_b32 v14, v6 offset:0
    s_waitcnt lgkmcnt(0)
    v_readfirstlane_b32 s58, v14
    s_nop 1
    s_cmp_eq_u32 s58, 0
    s_cbranch_scc1 L_k4_lw1
L_k4_go1:
    s_waitcnt lgkmcnt(0)
    s_add_u32 s15, s7, 0
    buffer_load_dwordx4 v[208:211], v5, s[52:55], s15 offen sc1
    buffer_load_dwordx4 v[212:215], v9, s[52:55], s15 offen sc1
    s_add_u32 s15, s7, 473088
    buffer_load_dwordx4 v[216:219], v5, s[52:55], s15 offen sc1
    buffer_load_dwordx4 v[220:223], v9, s[52:55], s15 offen sc1
    s_add_u32 s15, s7, 946176
    buffer_load_dwordx4 v[224:227], v5, s[52:55], s15 offen sc1
    buffer_load_dwordx4 v[228:231], v9, s[52:55], s15 offen sc1
    s_add_u32 s15, s7, 1419264
    buffer_load_dwordx4 v[232:235], v5, s[52:55], s15 offen sc1
    buffer_load_dwordx4 v[236:239], v9, s[52:55], s15 offen sc1
    s_add_u32 s15, s7, 67584
    buffer_load_dwordx4 v[240:243], v5, s[52:55], s15 offen sc1
    buffer_load_dwordx4 v[244:247], v9, s[52:55], s15 offen sc1
    s_add_u32 s15, s7, 540672
    buffer_load_dwordx4 v[248:251], v5, s[52:55], s15 offen sc1
    buffer_load_dwordx4 v[252:255], v9, s[52:55], s15 offen sc1
    s_waitcnt vmcnt(10)
    v_mfma_f32_32x32x16_bf16 v[144:159], v[16:19], v[208:211], 0
    v_mfma_f32_32x32x16_bf16 v[160:175], v[16:19], v[212:215], 0
    v_mfma_f32_32x32x16_bf16 v[176:191], v[20:23], v[208:211], 0
    v_mfma_f32_32x32x16_bf16 v[192:207], v[20:23], v[212:215], 0
    s_add_u32 s15, s7, 1013760
    buffer_load_dwordx4 v[208:211], v5, s[52:55], s15 offen sc1
    buffer_load_dwordx4 v[212:215], v9, s[52:55], s15 offen sc1
    s_add_u32 s15, s7, 1486848
    buffer_load_dwordx4 v[16:19], v5, s[52:55], s15 offen sc1
    buffer_load_dwordx4 v[20:23], v9, s[52:55], s15 offen sc1
    s_waitcnt vmcnt(12)
    v_mfma_f32_32x32x16_bf16 v[144:159], v[24:27], v[216:219], v[144:159]
    v_mfma_f32_32x32x16_bf16 v[160:175], v[24:27], v[220:223], v[160:175]
    v_mfma_f32_32x32x16_bf16 v[176:191], v[28:31], v[216:219], v[176:191]
    v_mfma_f32_32x32x16_bf16 v[192:207], v[28:31], v[220:223], v[192:207]
    s_add_u32 s15, s7, 135168
    buffer_load_dwordx4 v[216:219], v5, s[52:55], s15 offen sc1
    buffer_load_dwordx4 v[220:223], v9, s[52:55], s15 offen sc1
    s_add_u32 s15, s7, 608256
    buffer_load_dwordx4 v[24:27], v5, s[52:55], s15 offen sc1
    buffer_load_dwordx4 v[28:31], v9, s[52:55], s15 offen sc1
    s_waitcnt vmcnt(14)
    v_mfma_f32_32x32x16_bf16 v[144:159], v[32:35], v[224:227], v[144:159]
    v_mfma_f32_32x32x16_bf16 v[160:175], v[32:35], v[228:231], v[160:175]
    v_mfma_f32_32x32x16_bf16 v[176:191], v[36:39], v[224:227], v[176:191]
    v_mfma_f32_32x32x16_bf16 v[192:207], v[36:39], v[228:231], v[192:207]
    s_add_u32 s15, s7, 1081344
    buffer_load_dwordx4 v[224:227], v5, s[52:55], s15 offen sc1
    buffer_load_dwordx4 v[228:231], v9, s[52:55], s15 offen sc1
    s_waitcnt vmcnt(14)
    v_mfma_f32_32x32x16_bf16 v[144:159], v[40:43], v[232:235], v[144:159]
    v_mfma_f32_32x32x16_bf16 v[160:175], v[40:43], v[236:239], v[160:175]
    v_mfma_f32_32x32x16_bf16 v[176:191], v[44:47], v[232:235], v[176:191]
    v_mfma_f32_32x32x16_bf16 v[192:207], v[44:47], v[236:239], v[192:207]
    s_add_u32 s15, s7, 1554432
    buffer_load_dwordx4 v[232:235], v5, s[52:55], s15 offen sc1
    buffer_load_dwordx4 v[236:239], v9, s[52:55], s15 offen sc1
    s_waitcnt vmcnt(14)
    v_mfma_f32_32x32x16_bf16 v[144:159], v[48:51], v[240:243], v[144:159]
    v_mfma_f32_32x32x16_bf16 v[160:175], v[48:51], v[244:247], v[160:175]
    v_mfma_f32_32x32x16_bf16 v[176:191], v[52:55], v[240:243], v[176:191]
    v_mfma_f32_32x32x16_bf16 v[192:207], v[52:55], v[244:247], v[192:207]
    s_add_u32 s15, s7, 202752
    buffer_load_dwordx4 v[240:243], v5, s[52:55], s15 offen sc1
    buffer_load_dwordx4 v[244:247], v9, s[52:55], s15 offen sc1
    s_waitcnt vmcnt(14)
    v_mfma_f32_32x32x16_bf16 v[144:159], v[56:59], v[248:251], v[144:159]
    v_mfma_f32_32x32x16_bf16 v[160:175], v[56:59], v[252:255], v[160:175]
    v_mfma_f32_32x32x16_bf16 v[176:191], v[60:63], v[248:251], v[176:191]
    v_mfma_f32_32x32x16_bf16 v[192:207], v[60:63], v[252:255], v[192:207]
    s_add_u32 s15, s7, 675840
    buffer_load_dwordx4 v[248:251], v5, s[52:55], s15 offen sc1
    buffer_load_dwordx4 v[252:255], v9, s[52:55], s15 offen sc1
    s_waitcnt vmcnt(14)
    v_mfma_f32_32x32x16_bf16 v[144:159], v[64:67], v[208:211], v[144:159]
    v_mfma_f32_32x32x16_bf16 v[160:175], v[64:67], v[212:215], v[160:175]
    v_mfma_f32_32x32x16_bf16 v[176:191], v[68:71], v[208:211], v[176:191]
    v_mfma_f32_32x32x16_bf16 v[192:207], v[68:71], v[212:215], v[192:207]
    s_add_u32 s15, s7, 1148928
    buffer_load_dwordx4 v[208:211], v5, s[52:55], s15 offen sc1
    buffer_load_dwordx4 v[212:215], v9, s[52:55], s15 offen sc1
    s_add_u32 s15, s7, 1622016
    buffer_load_dwordx4 v[64:67], v5, s[52:55], s15 offen sc1
    buffer_load_dwordx4 v[68:71], v9, s[52:55], s15 offen sc1
    s_waitcnt vmcnt(16)
    v_mfma_f32_32x32x16_bf16 v[144:159], v[72:75], v[16:19], v[144:159]
    v_mfma_f32_32x32x16_bf16 v[160:175], v[72:75], v[20:23], v[160:175]
    v_mfma_f32_32x32x16_bf16 v[176:191], v[76:79], v[16:19], v[176:191]
    v_mfma_f32_32x32x16_bf16 v[192:207], v[76:79], v[20:23], v[192:207]
    s_add_u32 s15, s62, 12288
    s_add_u32 s14, s63, 12288
    buffer_load_dwordx4 v[16:19], v8, s[52:55], s15 offen
    buffer_load_dwordx4 v[20:23], v8, s[52:55], s14 offen
    s_add_u32 s15, s62, 26624
    s_add_u32 s14, s63, 26624
    buffer_load_dwordx4 v[72:75], v8, s[52:55], s15 offen
    buffer_load_dwordx4 v[76:79], v8, s[52:55], s14 offen
    s_waitcnt vmcnt(18)
    v_mfma_f32_32x32x16_bf16 v[144:159], v[80:83], v[216:219], v[144:159]
    v_mfma_f32_32x32x16_bf16 v[160:175], v[80:83], v[220:223], v[160:175]
    v_mfma_f32_32x32x16_bf16 v[176:191], v[84:87], v[216:219], v[176:191]
    v_mfma_f32_32x32x16_bf16 v[192:207], v[84:87], v[220:223], v[192:207]
    s_add_u32 s15, s62, 40960
    s_add_u32 s14, s63, 40960
    buffer_load_dwordx4 v[216:219], v8, s[52:55], s15 offen
    buffer_load_dwordx4 v[220:223], v8, s[52:55], s14 offen
    s_add_u32 s15, s62, 55296
    s_add_u32 s14, s63, 55296
    buffer_load_dwordx4 v[80:83], v8, s[52:55], s15 offen
    buffer_load_dwordx4 v[84:87], v8, s[52:55], s14 offen
    s_add_u32 s15, s65, 0
    buffer_load_dwordx4 v[32:35], v11, s[52:55], s15 offen offset:0
    buffer_load_dwordx4 v[36:39], v11, s[52:55], s15 offen offset:16
    s_add_u32 s15, s65, 10752
    buffer_load_dwordx4 v[40:43], v11, s[52:55], s15 offen offset:0
    buffer_load_dwordx4 v[44:47], v11, s[52:55], s15 offen offset:16
    s_add_u32 s15, s65, 0
    buffer_load_dwordx4 v[48:51], v11, s[52:55], s15 offen offset:64
    buffer_load_dwordx4 v[52:55], v11, s[52:55], s15 offen offset:80
    s_add_u32 s15, s65, 10752
    buffer_load_dwordx4 v[56:59], v11, s[52:55], s15 offen offset:64
    buffer_load_dwordx4 v[60:63], v11, s[52:55], s15 offen offset:80
    s_waitcnt vmcnt(28)
    v_mfma_f32_32x32x16_bf16 v[144:159], v[88:91], v[24:27], v[144:159]
    v_mfma_f32_32x32x16_bf16 v[160:175], v[88:91], v[28:31], v[160:175]
    v_mfma_f32_32x32x16_bf16 v[176:191], v[92:95], v[24:27], v[176:191]
    v_mfma_f32_32x32x16_bf16 v[192:207], v[92:95], v[28:31], v[192:207]
    s_waitcnt vmcnt(26)
    v_mfma_f32_32x32x16_bf16 v[144:159], v[96:99], v[224:227], v[144:159]
    v_mfma_f32_32x32x16_bf16 v[160:175], v[96:99], v[228:231], v[160:175]
    v_mfma_f32_32x32x16_bf16 v[176:191], v[100:103], v[224:227], v[176:191]
    v_mfma_f32_32x32x16_bf16 v[192:207], v[100:103], v[228:231], v[192:207]
    s_waitcnt vmcnt(24)
    v_mfma_f32_32x32x16_bf16 v[144:159], v[104:107], v[232:235], v[144:159]
    v_mfma_f32_32x32x16_bf16 v[160:175], v[104:107], v[236:239], v[160:175]
    v_mfma_f32_32x32x16_bf16 v[176:191], v[108:111], v[232:235], v[176:191]
    v_mfma_f32_32x32x16_bf16 v[192:207], v[108:111], v[236:239], v[192:207]
    s_waitcnt vmcnt(22)
    v_mfma_f32_32x32x16_bf16 v[144:159], v[112:115], v[240:243], v[144:159]
    v_mfma_f32_32x32x16_bf16 v[160:175], v[112:115], v[244:247], v[160:175]
    v_mfma_f32_32x32x16_bf16 v[176:191], v[116:119], v[240:243], v[176:191]
    v_mfma_f32_32x32x16_bf16 v[192:207], v[116:119], v[244:247], v[192:207]
    s_add_u32 s66, s66, 2048
    s_cmp_lg_u32 s4, 0
    s_cbranch_scc1 L_k4_lw2
    s_mov_b32 s67, 0
L_k4_poll2:
    buffer_load_dword v14, v13, s[52:55], s66 offen offset:2048 sc1
    s_waitcnt vmcnt(0)
    v_readfirstlane_b32 s58, v14
    s_add_u32 s67, s67, 1
    s_nop 0
    s_cmp_ge_u32 s58, 16
    s_cbranch_scc1 L_k4_set2
    s_sleep 2
    s_cmp_lt_u32 s67, 262144
    s_cbranch_scc1 L_k4_poll2
L_k4_set2:
    v_mov_b32 v14, 1
    ds_write_b32 v6, v14 offset:4
    s_branch L_k4_go2
L_k4_lw2:
    ds_read_b32 v14, v6 offset:4
    s_waitcnt lgkmcnt(0)
    v_readfirstlane_b32 s58, v14
    s_nop 1
    s_cmp_eq_u32 s58, 0
    s_cbranch_scc1 L_k4_lw2
L_k4_go2:
    s_waitcnt lgkmcnt(0)
    s_barrier
    s_add_u32 m0, s10, 0
    s_add_u32 s15, s9, 0
    buffer_load_dwordx4 v10, s[52:55], s15 offen lds
    s_add_u32 m0, s10, 1024
    s_add_u32 s15, s9, 69632
    buffer_load_dwordx4 v10, s[52:55], s15 offen lds
    s_add_u32 s15, s7, 270336
    buffer_load_dwordx4 v[24:27], v5, s[52:55], s15 offen sc1
    buffer_load_dwordx4 v[28:31], v9, s[52:55], s15 offen sc1
    s_add_u32 s15, s7, 743424
    buffer_load_dwordx4 v[88:91], v5, s[52:55], s15 offen sc1
    buffer_load_dwordx4 v[92:95], v9, s[52:55], s15 offen sc1
    s_add_u32 s15, s7, 1216512
    buffer_load_dwordx4 v[224:227], v5, s[52:55], s15 offen sc1
    buffer_load_dwordx4 v[228:231], v9, s[52:55], s15 offen sc1
    s_add_u32 s15, s7, 1689600
    buffer_load_dwordx4 v[96:99], v5, s[52:55], s15 offen sc1
    buffer_load_dwordx4 v[100:103], v9, s[52:55], s15 offen sc1
    s_add_u32 s15, s7, 337920
    buffer_load_dwordx4 v[232:235], v5, s[52:55], s15 offen sc1
    buffer_load_dwordx4 v[236:239], v9, s[52:55], s15 offen sc1
    s_add_u32 s15, s7, 811008
    buffer_load_dwordx4 v[104:107], v5, s[52:55], s15 offen sc1
    buffer_load_dwordx4 v[108:111], v9, s[52:55], s15 offen sc1
    s_add_u32 s15, s7, 1284096
    buffer_load_dwordx4 v[240:243], v5, s[52:55], s15 offen sc1
    buffer_load_dwordx4 v[244:247], v9, s[52:55], s15 offen sc1
    s_waitcnt vmcnt(36)
    v_mfma_f32_32x32x16_bf16 v[144:159], v[120:123], v[248:251], v[144:159]
    v_mfma_f32_32x32x16_bf16 v[160:175], v[120:123], v[252:255], v[160:175]
    v_mfma_f32_32x32x16_bf16 v[176:191], v[124:127], v[248:251], v[176:191]
    v_mfma_f32_32x32x16_bf16 v[192:207], v[124:127], v[252:255], v[192:207]
    s_add_u32 s15, s7, 1757184
    buffer_load_dwordx4 v[248:251], v5, s[52:55], s15 offen sc1
    buffer_load_dwordx4 v[252:255], v9, s[52:55], s15 offen sc1
    s_waitcnt vmcnt(36)
    v_mfma_f32_32x32x16_bf16 v[144:159], v[128:131], v[208:211], v[144:159]
    v_mfma_f32_32x32x16_bf16 v[160:175], v[128:131], v[212:215], v[160:175]
    v_mfma_f32_32x32x16_bf16 v[176:191], v[132:135], v[208:211], v[176:191]
    v_mfma_f32_32x32x16_bf16 v[192:207], v[132:135], v[212:215], v[192:207]
    ds_read_b128 v[112:115], v12 offset:0
    ds_read_b128 v[116:119], v12 offset:1024
    s_add_u32 s15, s7, 405504
    buffer_load_dwordx4 v[208:211], v5, s[52:55], s15 offen sc1
    buffer_load_dwordx4 v[212:215], v9, s[52:55], s15 offen sc1
    s_add_u32 s15, s7, 878592
    buffer_load_dwordx4 v[128:131], v5, s[52:55], s15 offen sc1
    buffer_load_dwordx4 v[132:135], v9, s[52:55], s15 offen sc1
    s_waitcnt vmcnt(38)
    v_mfma_f32_32x32x16_bf16 v[144:159], v[136:139], v[64:67], v[144:159]
    v_mfma_f32_32x32x16_bf16 v[160:175], v[136:139], v[68:71], v[160:175]
    v_mfma_f32_32x32x16_bf16 v[176:191], v[140:143], v[64:67], v[176:191]
    v_mfma_f32_32x32x16_bf16 v[192:207], v[140:143], v[68:71], v[192:207]
    ds_read_b128 v[120:123], v12 offset:2048
    ds_read_b128 v[124:127], v12 offset:3072
    s_add_u32 s15, s7, 1351680
    buffer_load_dwordx4 v[64:67], v5, s[52:55], s15 offen sc1
    buffer_load_dwordx4 v[68:71], v9, s[52:55], s15 offen sc1
    s_add_u32 s15, s7, 1824768
    buffer_load_dwordx4 v[136:139], v5, s[52:55], s15 offen sc1
    buffer_load_dwordx4 v[140:143], v9, s[52:55], s15 offen sc1
    s_waitcnt vmcnt(22)
    s_waitcnt lgkmcnt(2)
    v_mfma_f32_32x32x16_bf16 v[144:159], v[112:115], v[24:27], v[144:159]
    v_mfma_f32_32x32x16_bf16 v[160:175], v[112:115], v[28:31], v[160:175]
    v_mfma_f32_32x32x16_bf16 v[176:191], v[116:119], v[24:27], v[176:191]
    v_mfma_f32_32x32x16_bf16 v[192:207], v[116:119], v[28:31], v[192:207]
    ds_read_b128 v[112:115], v12 offset:4096
    ds_read_b128 v[116:119], v12 offset:5120
    s_waitcnt vmcnt(20)
    s_waitcnt lgkmcnt(2)
    v_mfma_f32_32x32x16_bf16 v[144:159], v[120:123], v[88:91], v[144:159]
    v_mfma_f32_32x32x16_bf16 v[160:175], v[120:123], v[92:95], v[160:175]
    v_mfma_f32_32x32x16_bf16 v[176:191], v[124:127], v[88:91], v[176:191]
    v_mfma_f32_32x32x16_bf16 v[192:207], v[124:127], v[92:95], v[192:207]
    ds_read_b128 v[120:123], v12 offset:6144
    ds_read_b128 v[124:127], v12 offset:7168
    s_waitcnt vmcnt(18)
    s_waitcnt lgkmcnt(2)
    v_mfma_f32_32x32x16_bf16 v[144:159], v[112:115], v[224:227], v[144:159]
    v_mfma_f32_32x32x16_bf16 v[160:175], v[112:115], v[228:231], v[160:175]
    v_mfma_f32_32x32x16_bf16 v[176:191], v[116:119], v[224:227], v[176:191]
    v_mfma_f32_32x32x16_bf16 v[192:207], v[116:119], v[228:231], v[192:207]
    ds_read_b128 v[112:115], v12 offset:8192
    ds_read_b128 v[116:119], v12 offset:9216
    s_waitcnt vmcnt(16)
    s_waitcnt lgkmcnt(2)
    v_mfma_f32_32x32x16_bf16 v[144:159], v[120:123], v[96:99], v[144:159]
    v_mfma_f32_32x32x16_bf16 v[160:175], v[120:123], v[100:103], v[160:175]
    v_mfma_f32_32x32x16_bf16 v[176:191], v[124:127], v[96:99], v[176:191]
    v_mfma_f32_32x32x16_bf16 v[192:207], v[124:127], v[100:103], v[192:207]
    ds_read_b128 v[120:123], v12 offset:10240
    ds_read_b128 v[124:127], v12 offset:11264
    s_waitcnt vmcnt(14)
    s_waitcnt lgkmcnt(2)
    v_mfma_f32_32x32x16_bf16 v[144:159], v[112:115], v[232:235], v[144:159]
    v_mfma_f32_32x32x16_bf16 v[160:175], v[112:115], v[236:239], v[160:175]
    v_mfma_f32_32x32x16_bf16 v[176:191], v[116:119], v[232:235], v[176:191]
    v_mfma_f32_32x32x16_bf16 v[192:207], v[116:119], v[236:239], v[192:207]
    ds_read_b128 v[112:115], v12 offset:12288
    ds_read_b128 v[116:119], v12 offset:13312
    v_add_f32 v32, v32, v40
    v_add_f32 v33, v33, v41
    v_add_f32 v34, v34, v42
    v_add_f32 v35, v35, v43
    v_add_f32 v36, v36, v44
    v_add_f32 v37, v37, v45
    v_add_f32 v38, v38, v46
    v_add_f32 v39, v39, v47
    v_cvt_pk_bf16_f32 v40, v32, v33
    v_cvt_pk_bf16_f32 v41, v34, v35
    v_cvt_pk_bf16_f32 v42, v36, v37
    v_cvt_pk_bf16_f32 v43, v38, v39
    v_lshlrev_b32 v32, 16, v40
    v_and_b32 v33, s6, v40
    v_lshlrev_b32 v34, 16, v41
    v_and_b32 v35, s6, v41
    v_lshlrev_b32 v36, 16, v42
    v_and_b32 v37, s6, v42
    v_lshlrev_b32 v38, 16, v43
    v_and_b32 v39, s6, v43
    v_add_f32 v48, v48, v56
    v_add_f32 v49, v49, v57
    v_add_f32 v50, v50, v58
    v_add_f32 v51, v51, v59
    v_add_f32 v52, v52, v60
    v_add_f32 v53, v53, v61
    v_add_f32 v54, v54, v62
    v_add_f32 v55, v55, v63
    v_cvt_pk_bf16_f32 v56, v48, v49
    v_cvt_pk_bf16_f32 v57, v50, v51
    v_cvt_pk_bf16_f32 v58, v52, v53
    v_cvt_pk_bf16_f32 v59, v54, v55
    v_lshlrev_b32 v48, 16, v56
    v_and_b32 v49, s6, v56
    v_lshlrev_b32 v50, 16, v57
    v_and_b32 v51, s6, v57
    v_lshlrev_b32 v52, 16, v58
    v_and_b32 v53, s6, v58
    v_lshlrev_b32 v54, 16, v59
    v_and_b32 v55, s6, v59
    s_waitcnt vmcnt(12)
    s_waitcnt lgkmcnt(2)
    v_mfma_f32_32x32x16_bf16 v[144:159], v[120:123], v[104:107], v[144:159]
    v_mfma_f32_32x32x16_bf16 v[160:175], v[120:123], v[108:111], v[160:175]
    v_mfma_f32_32x32x16_bf16 v[176:191], v[124:127], v[104:107], v[176:191]
    v_mfma_f32_32x32x16_bf16 v[192:207], v[124:127], v[108:111], v[192:207]
    ds_read_b128 v[120:123], v12 offset:14336
    ds_read_b128 v[124:127], v12 offset:15360
    s_waitcnt vmcnt(10)
    s_waitcnt lgkmcnt(2)
    v_mfma_f32_32x32x16_bf16 v[144:159], v[112:115], v[240:243], v[144:159]
    v_mfma_f32_32x32x16_bf16 v[160:175], v[112:115], v[244:247], v[160:175]
    v_mfma_f32_32x32x16_bf16 v[176:191], v[116:119], v[240:243], v[176:191]
    v_mfma_f32_32x32x16_bf16 v[192:207], v[116:119], v[244:247], v[192:207]
    s_waitcnt vmcnt(8)
    s_waitcnt lgkmcnt(0)
    v_mfma_f32_32x32x16_bf16 v[144:159], v[120:123], v[248:251], v[144:159]
    v_mfma_f32_32x32x16_bf16 v[160:175], v[120:123], v[252:255], v[160:175]
    v_mfma_f32_32x32x16_bf16 v[176:191], v[124:127], v[248:251], v[176:191]
    v_mfma_f32_32x32x16_bf16 v[192:207], v[124:127], v[252:255], v[192:207]
    s_waitcnt vmcnt(6)
    v_mfma_f32_32x32x16_bf16 v[144:159], v[16:19], v[208:211], v[144:159]
    v_mfma_f32_32x32x16_bf16 v[160:175], v[16:19], v[212:215], v[160:175]
    v_mfma_f32_32x32x16_bf16 v[176:191], v[20:23], v[208:211], v[176:191]
    v_mfma_f32_32x32x16_bf16 v[192:207], v[20:23], v[212:215], v[192:207]
    s_waitcnt vmcnt(4)
    v_mfma_f32_32x32x16_bf16 v[144:159], v[72:75], v[128:131], v[144:159]
    v_mfma_f32_32x32x16_bf16 v[160:175], v[72:75], v[132:135], v[160:175]
    v_mfma_f32_32x32x16_bf16 v[176:191], v[76:79], v[128:131], v[176:191]
    v_mfma_f32_32x32x16_bf16 v[192:207], v[76:79], v[132:135], v[192:207]
    s_waitcnt vmcnt(2)
    v_mfma_f32_32x32x16_bf16 v[144:159], v[216:219], v[64:67], v[144:159]
    v_mfma_f32_32x32x16_bf16 v[160:175], v[216:219], v[68:71], v[160:175]
    v_mfma_f32_32x32x16_bf16 v[176:191], v[220:223], v[64:67], v[176:191]
    v_mfma_f32_32x32x16_bf16 v[192:207], v[220:223], v[68:71], v[192:207]
    s_waitcnt vmcnt(0)
    v_mfma_f32_32x32x16_bf16 v[144:159], v[80:83], v[136:139], v[144:159]
    v_mfma_f32_32x32x16_bf16 v[160:175], v[80:83], v[140:143], v[160:175]
    v_mfma_f32_32x32x16_bf16 v[176:191], v[84:87], v[136:139], v[176:191]
    v_mfma_f32_32x32x16_bf16 v[192:207], v[84:87], v[140:143], v[192:207]
    s_xor_b32 s58, s4, 1
    s_mul_i32 s58, s58, 12288
    s_add_u32 s58, s58, 98304
    v_add_u32 v5, s58, v8
    s_nop 5
    ds_write_b128 v5, v[160:163] offset:0
    ds_write_b128 v5, v[164:167] offset:1024
    ds_write_b128 v5, v[168:171] offset:2048
    ds_write_b128 v5, v[172:175] offset:3072
    s_xor_b32 s58, s4, 2
    s_mul_i32 s58, s58, 12288
    s_add_u32 s58, s58, 102400
    v_add_u32 v9, s58, v8
    ds_write_b128 v9, v[176:179] offset:0
    ds_write_b128 v9, v[180:183] offset:1024
    ds_write_b128 v9, v[184:187] offset:2048
    ds_write_b128 v9, v[188:191] offset:3072
    s_xor_b32 s58, s4, 3
    s_mul_i32 s58, s58, 12288
    s_add_u32 s58, s58, 106496
    v_add_u32 v10, s58, v8
    ds_write_b128 v10, v[192:195] offset:0
    ds_write_b128 v10, v[196:199] offset:1024
    ds_write_b128 v10, v[200:203] offset:2048
    ds_write_b128 v10, v[204:207] offset:3072
    ds_read_b64_tr_b16 v[96:97], v3 offset:0
    ds_read_b64_tr_b16 v[98:99], v3 offset:256
    ds_read_b64_tr_b16 v[100:101], v3 offset:1024
    ds_read_b64_tr_b16 v[102:103], v3 offset:1280
    s_waitcnt lgkmcnt(0)
    v_lshlrev_b32 v104, 16, v96
    v_and_b32 v105, s6, v96
    v_lshlrev_b32 v106, 16, v97
    v_and_b32 v107, s6, v97
    v_lshlrev_b32 v108, 16, v98
    v_and_b32 v109, s6, v98
    v_lshlrev_b32 v110, 16, v99
    v_and_b32 v111, s6, v99
    v_lshlrev_b32 v112, 16, v100
    v_and_b32 v113, s6, v100
    v_lshlrev_b32 v114, 16, v101
    v_and_b32 v115, s6, v101
    v_lshlrev_b32 v116, 16, v102
    v_and_b32 v117, s6, v102
    v_lshlrev_b32 v118, 16, v103
    v_and_b32 v119, s6, v103
    s_waitcnt lgkmcnt(0)
    s_barrier
    ds_read_b128 v[208:211], v2 offset:0
    ds_read_b128 v[212:215], v2 offset:1024
    ds_read_b128 v[216:219], v2 offset:2048
    ds_read_b128 v[220:223], v2 offset:3072
    ds_read_b128 v[224:227], v2 offset:4096
    ds_read_b128 v[228:231], v2 offset:5120
    ds_read_b128 v[232:235], v2 offset:6144
    ds_read_b128 v[236:239], v2 offset:7168
    ds_read_b128 v[240:243], v2 offset:8192
    ds_read_b128 v[244:247], v2 offset:9216
    ds_read_b128 v[248:251], v2 offset:10240
    ds_read_b128 v[252:255], v2 offset:11264
    s_waitcnt lgkmcnt(8)
    v_add_f32 v144, v144, v208
    v_add_f32 v145, v145, v209
    v_add_f32 v146, v146, v210
    v_add_f32 v147, v147, v211
    v_add_f32 v148, v148, v212
    v_add_f32 v149, v149, v213
    v_add_f32 v150, v150, v214
    v_add_f32 v151, v151, v215
    v_add_f32 v152, v152, v216
    v_add_f32 v153, v153, v217
    v_add_f32 v154, v154, v218
    v_add_f32 v155, v155, v219
    v_add_f32 v156, v156, v220
    v_add_f32 v157, v157, v221
    v_add_f32 v158, v158, v222
    v_add_f32 v159, v159, v223
    s_waitcnt lgkmcnt(0)
    v_add_f32 v224, v224, v240
    v_add_f32 v225, v225, v241
    v_add_f32 v226, v226, v242
    v_add_f32 v227, v227, v243
    v_add_f32 v228, v228, v244
    v_add_f32 v229, v229, v245
    v_add_f32 v230, v230, v246
    v_add_f32 v231, v231, v247
    v_add_f32 v232, v232, v248
    v_add_f32 v233, v233, v249
    v_add_f32 v234, v234, v250
    v_add_f32 v235, v235, v251
    v_add_f32 v236, v236, v252
    v_add_f32 v237, v237, v253
    v_add_f32 v238, v238, v254
    v_add_f32 v239, v239, v255
    v_add_f32 v144, v144, v224
    v_add_f32 v145, v145, v225
    v_add_f32 v146, v146, v226
    v_add_f32 v147, v147, v227
    v_add_f32 v148, v148, v228
    v_add_f32 v149, v149, v229
    v_add_f32 v150, v150, v230
    v_add_f32 v151, v151, v231
    v_add_f32 v152, v152, v232
    v_add_f32 v153, v153, v233
    v_add_f32 v154, v154, v234
    v_add_f32 v155, v155, v235
    v_add_f32 v156, v156, v236
    v_add_f32 v157, v157, v237
    v_add_f32 v158, v158, v238
    v_add_f32 v159, v159, v239
    v_cvt_pk_bf16_f32 v96, v144, v145
    v_cvt_pk_bf16_f32 v97, v146, v147
    v_cvt_pk_bf16_f32 v98, v148, v149
    v_cvt_pk_bf16_f32 v99, v150, v151
    v_cvt_pk_bf16_f32 v100, v152, v153
    v_cvt_pk_bf16_f32 v101, v154, v155
    v_cvt_pk_bf16_f32 v102, v156, v157
    v_cvt_pk_bf16_f32 v103, v158, v159
    v_lshlrev_b32 v144, 16, v96
    v_and_b32 v145, s6, v96
    v_lshlrev_b32 v146, 16, v97
    v_and_b32 v147, s6, v97
    v_lshlrev_b32 v148, 16, v98
    v_and_b32 v149, s6, v98
    v_lshlrev_b32 v150, 16, v99
    v_and_b32 v151, s6, v99
    v_lshlrev_b32 v152, 16, v100
    v_and_b32 v153, s6, v100
    v_lshlrev_b32 v154, 16, v101
    v_and_b32 v155, s6, v101
    v_lshlrev_b32 v156, 16, v102
    v_and_b32 v157, s6, v102
    v_lshlrev_b32 v158, 16, v103
    v_and_b32 v159, s6, v103
    v_mul_f32 v144, v144, v32
    v_mul_f32 v145, v145, v33
    v_mul_f32 v146, v146, v34
    v_mul_f32 v147, v147, v35
    v_mul_f32 v148, v148, v36
    v_mul_f32 v149, v149, v37
    v_mul_f32 v150, v150, v38
    v_mul_f32 v151, v151, v39
    v_mul_f32 v152, v152, v48
    v_mul_f32 v153, v153, v49
    v_mul_f32 v154, v154, v50
    v_mul_f32 v155, v155, v51
    v_mul_f32 v156, v156, v52
    v_mul_f32 v157, v157, v53
    v_mul_f32 v158, v158, v54
    v_mul_f32 v159, v159, v55
    v_cvt_pk_bf16_f32 v96, v144, v145
    v_cvt_pk_bf16_f32 v97, v146, v147
    v_cvt_pk_bf16_f32 v98, v148, v149
    v_cvt_pk_bf16_f32 v99, v150, v151
    v_cvt_pk_bf16_f32 v100, v152, v153
    v_cvt_pk_bf16_f32 v101, v154, v155
    v_cvt_pk_bf16_f32 v102, v156, v157
    v_cvt_pk_bf16_f32 v103, v158, v159
    v_lshlrev_b32 v144, 16, v96
    v_and_b32 v145, s6, v96
    v_lshlrev_b32 v146, 16, v97
    v_and_b32 v147, s6, v97
    v_lshlrev_b32 v148, 16, v98
    v_and_b32 v149, s6, v98
    v_lshlrev_b32 v150, 16, v99
    v_and_b32 v151, s6, v99
    v_lshlrev_b32 v152, 16, v100
    v_and_b32 v153, s6, v100
    v_lshlrev_b32 v154, 16, v101
    v_and_b32 v155, s6, v101
    v_lshlrev_b32 v156, 16, v102
    v_and_b32 v157, s6, v102
    v_lshlrev_b32 v158, 16, v103
    v_and_b32 v159, s6, v103
    v_add_f32 v144, v144, v104
    v_add_f32 v145, v145, v105
    v_add_f32 v146, v146, v106
    v_add_f32 v147, v147, v107
    v_add_f32 v148, v148, v108
    v_add_f32 v149, v149, v109
    v_add_f32 v150, v150, v110
    v_add_f32 v151, v151, v111
    v_add_f32 v152, v152, v112
    v_add_f32 v153, v153, v113
    v_add_f32 v154, v154, v114
    v_add_f32 v155, v155, v115
    v_add_f32 v156, v156, v116
    v_add_f32 v157, v157, v117
    v_add_f32 v158, v158, v118
    v_add_f32 v159, v159, v119
    v_cvt_pk_bf16_f32 v96, v144, v145
    v_cvt_pk_bf16_f32 v97, v146, v147
    v_cvt_pk_bf16_f32 v98, v148, v149
    v_cvt_pk_bf16_f32 v99, v150, v151
    v_cvt_pk_bf16_f32 v100, v152, v153
    v_cvt_pk_bf16_f32 v101, v154, v155
    v_cvt_pk_bf16_f32 v102, v156, v157
    v_cvt_pk_bf16_f32 v103, v158, v159
    buffer_store_dwordx4 v[96:99], v15, s[68:71], s64 offen
    buffer_store_dwordx4 v[100:103], v15, s[68:71], s64 offen offset:32
    s_endpgm
.section .rodata,"a"
.p2align 6
.amdhsa_kernel k4_kernel
  .amdhsa_next_free_vgpr 256
  .amdhsa_next_free_sgpr 92
  .amdhsa_accum_offset 256
  .amdhsa_group_segment_fixed_size 0
  .amdhsa_kernarg_size 120
  .amdhsa_user_sgpr_count 2
  .amdhsa_user_sgpr_kernarg_segment_ptr 1
  .amdhsa_system_sgpr_workgroup_id_x 1
.end_amdhsa_kernel
.text
L_code_end:
    s_endpgm
```
